```python
import torch

def _softmax(x, axis=-1):
    return torch.softmax(x, dim=axis)
def _gelu(x):
    return torch.nn.functional.gelu(x, approximate="tanh")
def _silu(x):
    return torch.nn.functional.silu(x)
def _sigmoid(x):
    return torch.sigmoid(x)
def _layernorm(x, axis=-1, eps=1e-5):
    m = x.mean(dim=axis, keepdim=True)
    v = x.var(dim=axis, keepdim=True, unbiased=False)
    return (x - m) / torch.sqrt(v + eps)
def _scatter_add(tgt, idx, src, axis=0):
    return tgt.clone().index_add_(axis, idx, src)
def _segment_sum(src, seg, n):
    out = torch.zeros((n,) + src.shape[1:], dtype=src.dtype)
    return out.index_add_(0, seg, src)
def _pad(x, pw):
    flat = tuple(v for pair in reversed(pw) for v in pair)
    return torch.nn.functional.pad(x, flat)

kernel_name = 'concat_heads__ssm_conv_s5__ssm_conv_s4d__prompt'

def setup_inputs():

    _w = (lambda a: (lambda t: t.to(torch.bfloat16) if t.is_floating_point() else t)(torch.as_tensor(a)))
    def _A_setup():
        B, S, D = 1, 2048, 576
        P = D
        Lambda_re = -0.5 * (lambda _x: torch.exp(torch.as_tensor(_x)))((lambda *s: torch.randn(*s, dtype=torch.bfloat16) * 0.2)(P))
        Lambda_im = (lambda *s: torch.randn(*s, dtype=torch.bfloat16) * 0.4)(P) * 1.0
        B_re = (lambda *s: torch.randn(*s, dtype=torch.bfloat16) * 0.2)(P, D) * (D ** -0.5)
        B_im = (lambda *s: torch.randn(*s, dtype=torch.bfloat16) * 0.2)(P, D) * (D ** -0.5)
        C_re = (lambda *s: torch.randn(*s, dtype=torch.bfloat16) * 0.2)(D, P) * (P ** -0.5)
        C_im = (lambda *s: torch.randn(*s, dtype=torch.bfloat16) * 0.2)(D, P) * (P ** -0.5)
        log_dt = (lambda *s: torch.randn(*s, dtype=torch.bfloat16) * 0.2)(P) * 0.3 - 2.0
        Dskip = (lambda *s: torch.randn(*s, dtype=torch.bfloat16) * 0.05)(D)
        return {
            "x": _w((lambda *s: torch.randn(*s, dtype=torch.bfloat16) * 0.05)(B, S, D)),
            "Lambda_re": _w(Lambda_re),
            "Lambda_im": _w(Lambda_im),
            "B_re": _w(B_re),
            "B_im": _w(B_im),
            "C_re": _w(C_re),
            "C_im": _w(C_im),
            "log_dt": _w(log_dt),
            "Dskip": _w(Dskip),
        }
    _A_in = _A_setup()

    def _B_setup():
        Bsz, L, D, N = 1, 2048, 576, 128
        return {
            "u": _w((lambda *s: torch.randn(*s, dtype=torch.bfloat16) * 0.05)(Bsz, L, D)),
            "log_A_real": _w((lambda *s: torch.randn(*s, dtype=torch.bfloat16) * 3.2)(D, N) * 0.5),
            "A_imag": _w((lambda *s: torch.randn(*s, dtype=torch.bfloat16) * 0.05)(D, N) * 3.14),
            "C_real": _w((lambda *s: torch.randn(*s, dtype=torch.bfloat16) * 0.1)(D, N) / N ** 0.5),
            "C_imag": _w((lambda *s: torch.randn(*s, dtype=torch.bfloat16) * 0.1)(D, N) / N ** 0.5),
            "log_dt": _w((lambda *s: torch.randn(*s, dtype=torch.bfloat16) * 0.05)(D) * 0.5 - 4.0),
            "D_skip": _w((lambda *s: torch.randn(*s, dtype=torch.bfloat16) * 0.05)(D)),
        }
    _B_in = _B_setup()

    return {
        "A_x": _A_in["x"],
        "A_Lambda_re": _A_in["Lambda_re"],
        "A_Lambda_im": _A_in["Lambda_im"],
        "A_B_re": _A_in["B_re"],
        "A_B_im": _A_in["B_im"],
        "A_C_re": _A_in["C_re"],
        "A_C_im": _A_in["C_im"],
        "A_log_dt": _A_in["log_dt"],
        "A_Dskip": _A_in["Dskip"],
        "B_u": _B_in["u"],
        "B_log_A_real": _B_in["log_A_real"],
        "B_A_imag": _B_in["A_imag"],
        "B_C_real": _B_in["C_real"],
        "B_C_imag": _B_in["C_imag"],
        "B_log_dt": _B_in["log_dt"],
        "B_D_skip": _B_in["D_skip"],
    }

def reference(A_x, A_Lambda_re, A_Lambda_im, A_B_re, A_B_im, A_C_re, A_C_im, A_log_dt, A_Dskip, B_u, B_log_A_real, B_A_imag, B_C_real, B_C_imag, B_log_dt, B_D_skip):
    def _A_ref(x, Lambda_re, Lambda_im, B_re, B_im, C_re, C_im, log_dt, Dskip):
        Bsz, L, H = x.shape
        Lam = Lambda_re + 1j * Lambda_im
        Bmat = B_re + 1j * B_im
        Cmat = C_re + 1j * C_im
        dt = torch.exp(log_dt)
        Lam_bar = torch.exp(dt * Lam)
        B_bar = ((Lam_bar - 1.0) / Lam)[:, None] * Bmat
        Bu = torch.einsum("bld,pd->blp", x + 0j, B_bar)
        h = torch.zeros_like(Bu[:, 0, :])
        hs = []
        for t in range(L):
            h = Lam_bar[None, :] * h + Bu[:, t, :]
            hs.append(h)
        hseq = torch.stack(hs, 1)
        y = 2.0 * torch.einsum("blp,dp->bld", hseq, Cmat).real + x * Dskip[None, None, :]
        return y

    def _B_ref(u, log_A_real, A_imag, C_real, C_imag, log_dt, D_skip):
        L = u.shape[1]
        dt = torch.exp(log_dt)
        A = -torch.exp(log_A_real) + 1j * A_imag
        C = (C_real + 1j * C_imag) * dt[:, None]
        pos = (lambda x, dt: x.to(dt))(torch.arange(L), log_dt.dtype)
        P = torch.exp((A * dt[:, None])[:, :, None] * pos[None, None, :])
        K = 2.0 * torch.einsum("dn,dnl->dl", C, P).real
        L2 = 2 * L
        u_t = (lambda x, *d: x.permute(*d))(u, 0, 2, 1)
        Kf = (lambda x, *a, **k: torch.fft.rfft(x.float(), *a, **k))(K, L2)
        Uf = (lambda x, *a, **k: torch.fft.rfft(x.float(), *a, **k))(u_t, L2)
        y = (lambda x, *a, **k: torch.fft.irfft(x, *a, **k).to(torch.bfloat16))(Uf * Kf[None, :, :], L2)[:, :, :L]
        y = (lambda x, *d: x.permute(*d))(y, 0, 2, 1)
        return y + u * D_skip[None, None, :]

    a = _A_ref(A_x, A_Lambda_re, A_Lambda_im, A_B_re, A_B_im, A_C_re, A_C_im, A_log_dt, A_Dskip)
    b = _B_ref(B_u, B_log_A_real, B_A_imag, B_C_real, B_C_imag, B_log_dt, B_D_skip)
    return torch.concatenate([a, b], axis=-1)
```

```asm
; @launch grid=(256,1,1) block=(512,1,1) lds=163840
.amdgcn_target "amdgcn-amd-amdhsa--gfx950"
.text
.globl concat_heads__ssm_conv_s5__ssm_conv_s4d__prompt_kernel
.p2align 8
.type concat_heads__ssm_conv_s5__ssm_conv_s4d__prompt_kernel,@function
concat_heads__ssm_conv_s5__ssm_conv_s4d__prompt_kernel:
    s_load_dwordx16 s[4:19], s[0:1], 0
    s_load_dwordx16 s[20:35], s[0:1], 64
    s_load_dwordx4 s[36:39], s[0:1], 128
    s_load_dwordx2 s[40:41], s[0:1], 144
    s_cmp_ge_u32 s2, 256
    s_cbranch_scc1 L_end
    s_and_b32 s42, s2, 7
    s_lshr_b32 s43, s2, 3
    s_add_u32 s43, s43, 26
    s_and_b32 s43, s43, 31
    v_lshrrev_b32 v1, 6, v0
    v_and_b32 v2, 63, v0
    v_readfirstlane_b32 s44, v1
    s_cmp_ge_u32 s43, 9
    s_cselect_b32 s3, 1, 0
    s_lshl_b32 s45, s42, 1
    s_add_u32 s45, s45, s3
    s_mul_i32 s3, s3, 9
    s_sub_u32 s46, s43, s3
    s_cmp_lt_u32 s43, 30
    s_cbranch_scc1 L_nocode
    s_getpc_b64 s[96:97]
    s_and_b32 s96, s96, 0xffffff00
    v_lshlrev_b32 v3, 7, v0
    v_cmp_gt_u32 vcc, CODE_BYTES, v3
    s_nop 0
    s_and_saveexec_b64 s[94:95], vcc
    s_cbranch_execz L_nocode2
    global_load_dword v255, v3, s[96:97]
L_nocode2:
    s_mov_b64 exec, s[94:95]
L_nocode:
    s_cmp_ge_u32 s43, 18
    s_cbranch_scc1 L_B
    s_and_b32 s47, s45, 1
    s_lshl_b32 s47, s47, 2
    s_add_u32 s47, s47, s42
    s_cmp_lt_u32 s44, 4
    s_cbranch_scc1 L_A_compute
    s_sub_u32 s71, s44, 4
    s_and_b32 s64, s71, 1
    v_and_b32 v3, 7, v2
    v_lshrrev_b32 v4, 4, v2
    v_xor_b32 v5, v3, v4
    v_xor_b32 v6, 4, v5
    v_lshlrev_b32 v5, 4, v5
    v_lshlrev_b32 v6, 4, v6
    v_lshrrev_b32 v7, 5, v2
    v_bfe_u32 v8, v2, 3, 2
    v_lshrrev_b32 v9, 3, v2
    s_lshl_b32 s66, s45, 7
    s_lshr_b32 s67, s71, 1
    s_lshl_b32 s67, s67, 6
    s_add_u32 s66, s66, s67
    s_lshl_b32 s67, s64, 4
    s_add_u32 s66, s66, s67
    v_lshl_add_u32 v10, v7, 5, v8
    v_add_u32 v10, s66, v10
    v_mul_u32_u24 v10, 1152, v10
    s_lshl_b32 s66, s46, 6
    s_lshr_b32 s67, s71, 1
    s_lshl_b32 s67, s67, 5
    s_add_u32 s66, s66, s67
    v_add_u32 v11, s66, v9
    v_mul_u32_u24 v11, 1152, v11
    v_add_u32 v16, 0, v10
    v_add_u32 v16, v16, v5
    v_add_u32 v20, 0, v11
    v_add_u32 v20, v20, v5
    v_add_u32 v17, 4608, v10
    v_add_u32 v17, v17, v6
    v_add_u32 v21, 9216, v11
    v_add_u32 v21, v21, v6
    v_add_u32 v18, 9216, v10
    v_add_u32 v18, v18, v5
    v_add_u32 v22, 18432, v11
    v_add_u32 v22, v22, v5
    v_add_u32 v19, 13824, v10
    v_add_u32 v19, v19, v6
    v_add_u32 v23, 27648, v11
    v_add_u32 v23, v23, v6
    s_mov_b32 s72, s47
    s_add_u32 s73, s46, 1
    s_add_u32 s68, s72, 0
    s_and_b32 s68, s68, 7
    s_add_u32 s68, s68, s73
    s_sub_u32 s74, s68, 9
    s_cmp_ge_u32 s68, 9
    s_cselect_b32 s68, s74, s68
    s_lshl_b32 s68, s68, 7
    s_lshl_b32 s70, s71, 12
    s_mov_b32 s50, 0x240000
    s_mov_b32 s51, 0x20000
    s_mov_b32 s54, 0xa2000
    s_mov_b32 s55, 0x20000
    s_cmp_eq_u32 s64, 0
    s_waitcnt lgkmcnt(0)
    s_mov_b32 s48, s4
    s_mov_b32 s49, s5
    s_cselect_b32 s52, s10, s12
    s_cselect_b32 s53, s11, s13
    s_add_u32 m0, s70, 0
    s_nop 0
    buffer_load_dwordx4 v16, s[48:51], s68 offen  lds
    s_add_u32 m0, s70, 16384
    s_nop 0
    buffer_load_dwordx4 v20, s[52:55], s68 offen  lds
    s_add_u32 m0, s70, 1024
    s_nop 0
    buffer_load_dwordx4 v17, s[48:51], s68 offen  lds
    s_add_u32 m0, s70, 17408
    s_nop 0
    buffer_load_dwordx4 v21, s[52:55], s68 offen  lds
    s_add_u32 m0, s70, 2048
    s_nop 0
    buffer_load_dwordx4 v18, s[48:51], s68 offen  lds
    s_add_u32 m0, s70, 18432
    s_nop 0
    buffer_load_dwordx4 v22, s[52:55], s68 offen  lds
    s_add_u32 m0, s70, 3072
    s_nop 0
    buffer_load_dwordx4 v19, s[48:51], s68 offen  lds
    s_add_u32 m0, s70, 19456
    s_nop 0
    buffer_load_dwordx4 v23, s[52:55], s68 offen  lds
    s_add_u32 s68, s72, 1
    s_and_b32 s68, s68, 7
    s_add_u32 s68, s68, s73
    s_sub_u32 s74, s68, 9
    s_cmp_ge_u32 s68, 9
    s_cselect_b32 s68, s74, s68
    s_lshl_b32 s68, s68, 7
    s_add_u32 m0, s70, 32768
    s_nop 0
    buffer_load_dwordx4 v16, s[48:51], s68 offen  lds
    s_add_u32 m0, s70, 49152
    s_nop 0
    buffer_load_dwordx4 v20, s[52:55], s68 offen  lds
    s_waitcnt vmcnt(2)
    s_barrier
    s_add_u32 m0, s70, 33792
    s_nop 0
    buffer_load_dwordx4 v17, s[48:51], s68 offen  lds
    s_add_u32 m0, s70, 50176
    s_nop 0
    buffer_load_dwordx4 v21, s[52:55], s68 offen  lds
    s_add_u32 m0, s70, 34816
    s_nop 0
    buffer_load_dwordx4 v18, s[48:51], s68 offen  lds
    s_add_u32 m0, s70, 51200
    s_nop 0
    buffer_load_dwordx4 v22, s[52:55], s68 offen  lds
    s_add_u32 m0, s70, 35840
    s_nop 0
    buffer_load_dwordx4 v19, s[48:51], s68 offen  lds
    s_add_u32 m0, s70, 52224
    s_nop 0
    buffer_load_dwordx4 v23, s[52:55], s68 offen  lds
    s_mov_b32 s56, s14
    s_mov_b32 s57, s15
    s_mov_b32 s58, 0xa2000
    s_mov_b32 s59, 0x20000
    s_mov_b32 s60, s16
    s_mov_b32 s61, s17
    s_mov_b32 s62, 0xa2000
    s_mov_b32 s63, 0x20000
    s_lshl_b32 s66, s46, 6
    s_lshl_b32 s67, s71, 4
    s_add_u32 s66, s66, s67
    v_add_u32 v10, s66, v9
    v_mul_u32_u24 v10, 1152, v10
    v_add_u32 v24, v10, v5
    v_add_u32 v25, 9216, v10
    v_add_u32 v25, v25, v6
    s_lshl_b32 s69, s71, 11
    s_add_u32 s68, s72, 2
    s_and_b32 s68, s68, 7
    s_add_u32 s68, s68, s73
    s_sub_u32 s74, s68, 9
    s_cmp_ge_u32 s68, 9
    s_cselect_b32 s68, s74, s68
    s_lshl_b32 s68, s68, 7
    s_add_u32 m0, s70, 65536
    s_nop 0
    buffer_load_dwordx4 v16, s[48:51], s68 offen  lds
    s_add_u32 m0, s70, 81920
    s_nop 0
    buffer_load_dwordx4 v20, s[52:55], s68 offen  lds
    s_add_u32 m0, s70, 66560
    s_nop 0
    buffer_load_dwordx4 v17, s[48:51], s68 offen  lds
    s_add_u32 m0, s70, 82944
    s_nop 0
    buffer_load_dwordx4 v21, s[52:55], s68 offen  lds
    s_add_u32 m0, s70, 67584
    s_nop 0
    buffer_load_dwordx4 v18, s[48:51], s68 offen  lds
    s_add_u32 m0, s70, 83968
    s_nop 0
    buffer_load_dwordx4 v22, s[52:55], s68 offen  lds
    s_add_u32 m0, s70, 68608
    s_nop 0
    buffer_load_dwordx4 v19, s[48:51], s68 offen  lds
    s_add_u32 m0, s70, 84992
    s_nop 0
    buffer_load_dwordx4 v23, s[52:55], s68 offen  lds
    s_add_u32 s68, s72, 3
    s_and_b32 s68, s68, 7
    s_add_u32 s68, s68, s73
    s_sub_u32 s74, s68, 9
    s_cmp_ge_u32 s68, 9
    s_cselect_b32 s68, s74, s68
    s_lshl_b32 s68, s68, 7
    s_add_u32 m0, s70, 98304
    s_nop 0
    buffer_load_dwordx4 v16, s[48:51], s68 offen  lds
    s_add_u32 m0, s70, 114688
    s_nop 0
    buffer_load_dwordx4 v20, s[52:55], s68 offen  lds
    s_add_u32 m0, s70, 99328
    s_nop 0
    buffer_load_dwordx4 v17, s[48:51], s68 offen  lds
    s_add_u32 m0, s70, 115712
    s_nop 0
    buffer_load_dwordx4 v21, s[52:55], s68 offen  lds
    s_waitcnt vmcnt(12)
    s_barrier
    s_add_u32 m0, s70, 100352
    s_nop 0
    buffer_load_dwordx4 v18, s[48:51], s68 offen  lds
    s_add_u32 m0, s70, 116736
    s_nop 0
    buffer_load_dwordx4 v22, s[52:55], s68 offen  lds
    s_add_u32 m0, s70, 101376
    s_nop 0
    buffer_load_dwordx4 v19, s[48:51], s68 offen  lds
    s_add_u32 m0, s70, 117760
    s_nop 0
    buffer_load_dwordx4 v23, s[52:55], s68 offen  lds
    s_add_u32 s68, s72, 4
    s_and_b32 s68, s68, 7
    s_add_u32 s68, s68, s73
    s_sub_u32 s74, s68, 9
    s_cmp_ge_u32 s68, 9
    s_cselect_b32 s68, s74, s68
    s_lshl_b32 s68, s68, 7
    s_add_u32 m0, s70, 131072
    s_nop 0
    buffer_load_dwordx4 v16, s[48:51], s68 offen  lds
    s_add_u32 m0, s70, 147456
    s_nop 0
    buffer_load_dwordx4 v20, s[52:55], s68 offen  lds
    s_add_u32 m0, s70, 132096
    s_nop 0
    buffer_load_dwordx4 v17, s[48:51], s68 offen  lds
    s_add_u32 m0, s70, 148480
    s_nop 0
    buffer_load_dwordx4 v21, s[52:55], s68 offen  lds
    s_waitcnt vmcnt(12)
    s_barrier
    s_add_u32 m0, s70, 133120
    s_nop 0
    buffer_load_dwordx4 v18, s[48:51], s68 offen  lds
    s_add_u32 m0, s70, 149504
    s_nop 0
    buffer_load_dwordx4 v22, s[52:55], s68 offen  lds
    s_add_u32 m0, s70, 134144
    s_nop 0
    buffer_load_dwordx4 v19, s[48:51], s68 offen  lds
    s_add_u32 m0, s70, 150528
    s_nop 0
    buffer_load_dwordx4 v23, s[52:55], s68 offen  lds
    s_add_u32 s68, s72, 5
    s_and_b32 s68, s68, 7
    s_add_u32 s68, s68, s73
    s_sub_u32 s74, s68, 9
    s_cmp_ge_u32 s68, 9
    s_cselect_b32 s68, s74, s68
    s_lshl_b32 s68, s68, 7
    s_add_u32 m0, s70, 0
    s_nop 0
    buffer_load_dwordx4 v16, s[48:51], s68 offen  lds
    s_add_u32 m0, s70, 16384
    s_nop 0
    buffer_load_dwordx4 v20, s[52:55], s68 offen  lds
    s_add_u32 m0, s70, 1024
    s_nop 0
    buffer_load_dwordx4 v17, s[48:51], s68 offen  lds
    s_add_u32 m0, s70, 17408
    s_nop 0
    buffer_load_dwordx4 v21, s[52:55], s68 offen  lds
    s_waitcnt vmcnt(12)
    s_barrier
    s_add_u32 m0, s70, 2048
    s_nop 0
    buffer_load_dwordx4 v18, s[48:51], s68 offen  lds
    s_add_u32 m0, s70, 18432
    s_nop 0
    buffer_load_dwordx4 v22, s[52:55], s68 offen  lds
    s_add_u32 m0, s70, 3072
    s_nop 0
    buffer_load_dwordx4 v19, s[48:51], s68 offen  lds
    s_add_u32 m0, s70, 19456
    s_nop 0
    buffer_load_dwordx4 v23, s[52:55], s68 offen  lds
    s_add_u32 s68, s72, 6
    s_and_b32 s68, s68, 7
    s_add_u32 s68, s68, s73
    s_sub_u32 s74, s68, 9
    s_cmp_ge_u32 s68, 9
    s_cselect_b32 s68, s74, s68
    s_lshl_b32 s68, s68, 7
    s_add_u32 m0, s70, 32768
    s_nop 0
    buffer_load_dwordx4 v16, s[48:51], s68 offen  lds
    s_add_u32 m0, s70, 49152
    s_nop 0
    buffer_load_dwordx4 v20, s[52:55], s68 offen  lds
    s_add_u32 m0, s70, 33792
    s_nop 0
    buffer_load_dwordx4 v17, s[48:51], s68 offen  lds
    s_add_u32 m0, s70, 50176
    s_nop 0
    buffer_load_dwordx4 v21, s[52:55], s68 offen  lds
    s_waitcnt vmcnt(12)
    s_barrier
    s_add_u32 m0, s70, 34816
    s_nop 0
    buffer_load_dwordx4 v18, s[48:51], s68 offen  lds
    s_add_u32 m0, s70, 51200
    s_nop 0
    buffer_load_dwordx4 v22, s[52:55], s68 offen  lds
    s_add_u32 m0, s70, 35840
    s_nop 0
    buffer_load_dwordx4 v19, s[48:51], s68 offen  lds
    s_add_u32 m0, s70, 52224
    s_nop 0
    buffer_load_dwordx4 v23, s[52:55], s68 offen  lds
    s_add_u32 s68, s72, 7
    s_and_b32 s68, s68, 7
    s_add_u32 s68, s68, s73
    s_sub_u32 s74, s68, 9
    s_cmp_ge_u32 s68, 9
    s_cselect_b32 s68, s74, s68
    s_lshl_b32 s68, s68, 7
    s_add_u32 m0, s70, 65536
    s_nop 0
    buffer_load_dwordx4 v16, s[48:51], s68 offen  lds
    s_add_u32 m0, s70, 81920
    s_nop 0
    buffer_load_dwordx4 v20, s[52:55], s68 offen  lds
    s_add_u32 m0, s70, 66560
    s_nop 0
    buffer_load_dwordx4 v17, s[48:51], s68 offen  lds
    s_add_u32 m0, s70, 82944
    s_nop 0
    buffer_load_dwordx4 v21, s[52:55], s68 offen  lds
    s_waitcnt vmcnt(12)
    s_barrier
    s_add_u32 m0, s70, 67584
    s_nop 0
    buffer_load_dwordx4 v18, s[48:51], s68 offen  lds
    s_add_u32 m0, s70, 83968
    s_nop 0
    buffer_load_dwordx4 v22, s[52:55], s68 offen  lds
    s_add_u32 m0, s70, 68608
    s_nop 0
    buffer_load_dwordx4 v19, s[48:51], s68 offen  lds
    s_add_u32 m0, s70, 84992
    s_nop 0
    buffer_load_dwordx4 v23, s[52:55], s68 offen  lds
    s_lshl_b32 s68, s46, 7
    s_add_u32 m0, s70, 98304
    s_nop 0
    buffer_load_dwordx4 v16, s[48:51], s68 offen  lds
    s_add_u32 m0, s70, 114688
    s_nop 0
    buffer_load_dwordx4 v20, s[52:55], s68 offen  lds
    s_add_u32 m0, s70, 99328
    s_nop 0
    buffer_load_dwordx4 v17, s[48:51], s68 offen  lds
    s_add_u32 m0, s70, 115712
    s_nop 0
    buffer_load_dwordx4 v21, s[52:55], s68 offen  lds
    s_waitcnt vmcnt(12)
    s_barrier
    s_add_u32 m0, s70, 100352
    s_nop 0
    buffer_load_dwordx4 v18, s[48:51], s68 offen  lds
    s_add_u32 m0, s70, 116736
    s_nop 0
    buffer_load_dwordx4 v22, s[52:55], s68 offen  lds
    s_add_u32 m0, s70, 101376
    s_nop 0
    buffer_load_dwordx4 v19, s[48:51], s68 offen  lds
    s_add_u32 m0, s70, 117760
    s_nop 0
    buffer_load_dwordx4 v23, s[52:55], s68 offen  lds
    s_add_u32 s68, s72, 7
    s_and_b32 s68, s68, 7
    s_add_u32 s68, s68, s73
    s_sub_u32 s74, s68, 9
    s_cmp_ge_u32 s68, 9
    s_cselect_b32 s68, s74, s68
    s_lshl_b32 s68, s68, 7
    s_add_u32 m0, s69, 131072
    s_nop 0
    buffer_load_dwordx4 v24, s[56:59], s68 offen lds
    s_add_u32 m0, s69, 132096
    s_nop 0
    buffer_load_dwordx4 v25, s[56:59], s68 offen lds
    s_add_u32 m0, s69, 139264
    s_nop 0
    buffer_load_dwordx4 v24, s[60:63], s68 offen lds
    s_add_u32 m0, s69, 140288
    s_nop 0
    buffer_load_dwordx4 v25, s[60:63], s68 offen lds
    s_waitcnt vmcnt(12)
    s_barrier
    s_lshl_b32 s68, s46, 7
    s_add_u32 m0, s69, 0
    s_nop 0
    buffer_load_dwordx4 v24, s[56:59], s68 offen lds
    s_add_u32 m0, s69, 1024
    s_nop 0
    buffer_load_dwordx4 v25, s[56:59], s68 offen lds
    s_add_u32 m0, s69, 8192
    s_nop 0
    buffer_load_dwordx4 v24, s[60:63], s68 offen lds
    s_add_u32 m0, s69, 9216
    s_nop 0
    buffer_load_dwordx4 v25, s[60:63], s68 offen lds
    s_add_u32 s68, s72, 0
    s_and_b32 s68, s68, 7
    s_add_u32 s68, s68, s73
    s_sub_u32 s74, s68, 9
    s_cmp_ge_u32 s68, 9
    s_cselect_b32 s68, s74, s68
    s_lshl_b32 s68, s68, 7
    s_add_u32 m0, s69, 16384
    s_nop 0
    buffer_load_dwordx4 v24, s[56:59], s68 offen lds
    s_add_u32 m0, s69, 17408
    s_nop 0
    buffer_load_dwordx4 v25, s[56:59], s68 offen lds
    s_add_u32 m0, s69, 24576
    s_nop 0
    buffer_load_dwordx4 v24, s[60:63], s68 offen lds
    s_add_u32 m0, s69, 25600
    s_nop 0
    buffer_load_dwordx4 v25, s[60:63], s68 offen lds
    s_waitcnt vmcnt(12)
    s_barrier
    s_add_u32 s68, s72, 1
    s_and_b32 s68, s68, 7
    s_add_u32 s68, s68, s73
    s_sub_u32 s74, s68, 9
    s_cmp_ge_u32 s68, 9
    s_cselect_b32 s68, s74, s68
    s_lshl_b32 s68, s68, 7
    s_add_u32 m0, s69, 32768
    s_nop 0
    buffer_load_dwordx4 v24, s[56:59], s68 offen lds
    s_add_u32 m0, s69, 33792
    s_nop 0
    buffer_load_dwordx4 v25, s[56:59], s68 offen lds
    s_add_u32 m0, s69, 40960
    s_nop 0
    buffer_load_dwordx4 v24, s[60:63], s68 offen lds
    s_add_u32 m0, s69, 41984
    s_nop 0
    buffer_load_dwordx4 v25, s[60:63], s68 offen lds
    s_add_u32 s68, s72, 2
    s_and_b32 s68, s68, 7
    s_add_u32 s68, s68, s73
    s_sub_u32 s74, s68, 9
    s_cmp_ge_u32 s68, 9
    s_cselect_b32 s68, s74, s68
    s_lshl_b32 s68, s68, 7
    s_add_u32 m0, s69, 49152
    s_nop 0
    buffer_load_dwordx4 v24, s[56:59], s68 offen lds
    s_add_u32 m0, s69, 50176
    s_nop 0
    buffer_load_dwordx4 v25, s[56:59], s68 offen lds
    s_add_u32 m0, s69, 57344
    s_nop 0
    buffer_load_dwordx4 v24, s[60:63], s68 offen lds
    s_add_u32 m0, s69, 58368
    s_nop 0
    buffer_load_dwordx4 v25, s[60:63], s68 offen lds
    s_waitcnt vmcnt(0)
    s_barrier
    s_add_u32 s68, s72, 3
    s_and_b32 s68, s68, 7
    s_add_u32 s68, s68, s73
    s_sub_u32 s74, s68, 9
    s_cmp_ge_u32 s68, 9
    s_cselect_b32 s68, s74, s68
    s_lshl_b32 s68, s68, 7
    s_add_u32 m0, s69, 65536
    s_waitcnt vmcnt(4)
    buffer_load_dwordx4 v24, s[56:59], s68 offen lds
    s_add_u32 m0, s69, 66560
    s_waitcnt vmcnt(4)
    buffer_load_dwordx4 v25, s[56:59], s68 offen lds
    s_add_u32 m0, s69, 73728
    s_waitcnt vmcnt(4)
    buffer_load_dwordx4 v24, s[60:63], s68 offen lds
    s_add_u32 m0, s69, 74752
    s_waitcnt vmcnt(4)
    buffer_load_dwordx4 v25, s[60:63], s68 offen lds
    s_add_u32 s68, s72, 4
    s_and_b32 s68, s68, 7
    s_add_u32 s68, s68, s73
    s_sub_u32 s74, s68, 9
    s_cmp_ge_u32 s68, 9
    s_cselect_b32 s68, s74, s68
    s_lshl_b32 s68, s68, 7
    s_add_u32 m0, s69, 81920
    s_waitcnt vmcnt(4)
    buffer_load_dwordx4 v24, s[56:59], s68 offen lds
    s_add_u32 m0, s69, 82944
    s_waitcnt vmcnt(4)
    buffer_load_dwordx4 v25, s[56:59], s68 offen lds
    s_add_u32 m0, s69, 90112
    s_waitcnt vmcnt(4)
    buffer_load_dwordx4 v24, s[60:63], s68 offen lds
    s_add_u32 m0, s69, 91136
    s_waitcnt vmcnt(4)
    buffer_load_dwordx4 v25, s[60:63], s68 offen lds
    s_add_u32 s68, s72, 5
    s_and_b32 s68, s68, 7
    s_add_u32 s68, s68, s73
    s_sub_u32 s74, s68, 9
    s_cmp_ge_u32 s68, 9
    s_cselect_b32 s68, s74, s68
    s_lshl_b32 s68, s68, 7
    s_add_u32 m0, s69, 98304
    s_waitcnt vmcnt(4)
    buffer_load_dwordx4 v24, s[56:59], s68 offen lds
    s_add_u32 m0, s69, 99328
    s_waitcnt vmcnt(4)
    buffer_load_dwordx4 v25, s[56:59], s68 offen lds
    s_add_u32 m0, s69, 106496
    s_waitcnt vmcnt(4)
    buffer_load_dwordx4 v24, s[60:63], s68 offen lds
    s_add_u32 m0, s69, 107520
    s_waitcnt vmcnt(4)
    buffer_load_dwordx4 v25, s[60:63], s68 offen lds
    s_add_u32 s68, s72, 6
    s_and_b32 s68, s68, 7
    s_add_u32 s68, s68, s73
    s_sub_u32 s74, s68, 9
    s_cmp_ge_u32 s68, 9
    s_cselect_b32 s68, s74, s68
    s_lshl_b32 s68, s68, 7
    s_add_u32 m0, s69, 114688
    s_waitcnt vmcnt(4)
    buffer_load_dwordx4 v24, s[56:59], s68 offen lds
    s_add_u32 m0, s69, 115712
    s_waitcnt vmcnt(4)
    buffer_load_dwordx4 v25, s[56:59], s68 offen lds
    s_add_u32 m0, s69, 122880
    s_waitcnt vmcnt(4)
    buffer_load_dwordx4 v24, s[60:63], s68 offen lds
    s_add_u32 m0, s69, 123904
    s_waitcnt vmcnt(4)
    buffer_load_dwordx4 v25, s[60:63], s68 offen lds
    s_add_u32 s48, s40, 0x4a4000
    s_addc_u32 s49, s41, 0
    s_mov_b32 s50, 0x4800
    s_mov_b32 s51, 0x20000
    v_min_u32 v4, 8, v2
    v_lshlrev_b32 v4, 7, v4
    s_mul_i32 s66, s45, 1152
    v_add_u32 v4, s66, v4
    s_lshl_b32 s67, s46, 7
    s_add_u32 s66, s66, s67
    v_mov_b32 v5, s66
    v_mov_b32 v6, 1
    s_waitcnt vmcnt(0)
    s_barrier
    s_cmp_lg_u32 s71, 0
    s_cbranch_scc1 L_L_done
    s_mov_b64 exec, 1
    buffer_store_dword v6, v5, s[48:51], 0 offen sc1
    s_mov_b64 exec, -1
    s_sleep 4
    s_mov_b32 s66, 200000
L_L_pollF:
    buffer_load_dword v8, v4, s[48:51], 0 offen sc1
    s_waitcnt vmcnt(0)
    v_cmp_ne_u32 vcc, 1, v8
    s_nop 0
    s_cmp_eq_u64 vcc, 0
    s_cbranch_scc1 L_L_done
    s_sub_u32 s66, s66, 1
    s_cmp_eq_u32 s66, 0
    s_cbranch_scc0 L_L_pollF
L_L_done:
    s_barrier
    s_endpgm
    .p2align 6
L_A_compute:
    s_lshr_b32 s68, s44, 1
    s_and_b32 s64, s44, 1
    s_lshl_b32 s65, s45, 1
    s_add_u32 s65, s65, s68
    v_and_b32 v3, 31, v2
    v_lshrrev_b32 v4, 5, v2
    s_lshl_b32 s66, s46, 6
    s_lshl_b32 s67, s64, 5
    s_add_u32 s66, s66, s67
    v_add_u32 v5, s66, v3
    v_lshlrev_b32 v6, 1, v5
    s_mul_i32 s66, s45, 9216
    v_lshlrev_b32 v7, 4, v5
    v_add_u32 v41, s66, v7
    s_lshl_b32 s66, s68, 3
    v_add_u32 v36, s66, v41
    v_mul_u32_u24 v7, 9216, v4
    v_sub_u32 v41, v41, v7
    v_subrev_u32 v41, 9216, v41
    s_mul_i32 s66, s65, 144
    s_lshl_b32 s67, s46, 3
    s_add_u32 s66, s66, s67
    s_lshl_b32 s67, s64, 1
    s_add_u32 s66, s66, s67
    s_lshl_b32 s66, s66, 10
    v_lshlrev_b32 v39, 4, v2
    v_add_u32 v38, s66, v39
    s_waitcnt lgkmcnt(0)
    s_mov_b32 s48, s6
    s_mov_b32 s49, s7
    s_mov_b32 s50, 0x480
    s_mov_b32 s51, 0x20000
    s_mov_b32 s52, s8
    s_mov_b32 s53, s9
    s_mov_b32 s54, 0x480
    s_mov_b32 s55, 0x20000
    s_mov_b32 s56, s18
    s_mov_b32 s57, s19
    s_mov_b32 s58, 0x480
    s_mov_b32 s59, 0x20000
    buffer_load_ushort v24, v6, s[48:51], 0 offen
    buffer_load_ushort v25, v6, s[52:55], 0 offen
    buffer_load_ushort v26, v6, s[56:59], 0 offen
    s_add_u32 s60, s40, 0x480000
    s_addc_u32 s61, s41, 0
    s_mov_b32 s62, 0x28800
    s_mov_b32 s63, 0x20000
    s_mov_b32 s72, s38
    s_mov_b32 s73, s39
    s_mov_b32 s74, 0x100
    s_mov_b32 s75, 0x20000
    s_mov_b32 s76, s40
    s_mov_b32 s77, s41
    s_mov_b32 s78, 0x480000
    s_mov_b32 s79, 0x20000
    v_bfe_u32 v6, v2, 1, 3
    v_xor_b32 v6, v6, v4
    v_lshlrev_b32 v7, 7, v3
    s_lshl_b32 s66, s68, 13
    s_lshl_b32 s67, s64, 13
    s_add_u32 s67, s67, 16384
    v_xor_b32 v16, 0, v6
    v_lshl_add_u32 v16, v16, 4, v7
    v_add_u32 v8, s66, v16
    v_add_u32 v12, s67, v16
    v_xor_b32 v17, 2, v6
    v_lshl_add_u32 v17, v17, 4, v7
    v_add_u32 v9, s66, v17
    v_add_u32 v13, s67, v17
    v_xor_b32 v18, 4, v6
    v_lshl_add_u32 v18, v18, 4, v7
    v_add_u32 v10, s66, v18
    v_add_u32 v14, s67, v18
    v_xor_b32 v19, 6, v6
    v_lshl_add_u32 v19, v19, 4, v7
    v_add_u32 v11, s66, v19
    v_add_u32 v15, s67, v19
    s_movk_i32 s69, 4096
    s_mov_b32 s70, 73728
    s_mov_b32 s71, 77824
    s_lshl_b32 s66, s44, 12
    s_add_u32 s66, s66, 147456
    v_and_b32 v28, 7, v3
    v_lshlrev_b32 v29, 2, v4
    v_xor_b32 v28, v28, v29
    v_add_u32 v29, s66, v7
    v_xor_b32 v32, 0, v28
    v_lshl_add_u32 v32, v32, 4, v29
    v_xor_b32 v33, 1, v28
    v_lshl_add_u32 v33, v33, 4, v29
    v_xor_b32 v34, 2, v28
    v_lshl_add_u32 v34, v34, 4, v29
    v_xor_b32 v35, 3, v28
    v_lshl_add_u32 v35, v35, 4, v29
    v_bfe_u32 v28, v2, 2, 2
    v_bfe_u32 v29, v2, 4, 1
    v_bfe_u32 v30, v2, 1, 1
    v_lshl_add_u32 v29, v29, 1, v30
    v_xor_b32 v29, v29, v28
    v_lshlrev_b32 v29, 4, v29
    v_and_b32 v30, 1, v2
    v_lshl_add_u32 v29, v30, 3, v29
    v_lshl_add_u32 v28, v4, 3, v28
    v_lshl_add_u32 v29, v28, 7, v29
    v_add_u32 v45, s66, v29
    s_lshl_b32 s66, s64, 12
    s_add_u32 s66, s66, 155648
    v_lshlrev_b32 v37, 3, v2
    v_add_u32 v37, s66, v37
    s_lshl_b32 s66, s45, 2
    s_add_u32 s66, s66, s44
    s_mul_i32 s66, s66, 73728
    v_add_u32 v39, s66, v39
    v_add_u32 v40, 4096, v39
    s_lshl_b32 s66, s45, 7
    s_lshl_b32 s67, s44, 5
    s_add_u32 s66, s66, s67
    v_lshlrev_b32 v5, 2, v4
    v_add_u32 v5, s66, v5
    v_mul_u32_u24 v5, 4608, v5
    s_lshl_b32 s66, s46, 8
    v_lshl_add_u32 v5, v3, 2, v5
    v_add_u32 v5, s66, v5
    s_lshl_b32 s66, s46, 7
    v_lshlrev_b32 v6, 4, v4
    v_add_u32 v6, s66, v6
    v_lshrrev_b32 v28, 2, v3
    v_and_b32 v29, 3, v3
    v_lshl_add_u32 v28, v28, 3, v29
    s_lshl_b32 s66, s68, 6
    s_lshl_b32 s67, s64, 2
    s_add_u32 s66, s66, s67
    v_add_u32 v28, s66, v28
    v_bfe_u32 v29, v28, 1, 3
    v_xor_b32 v29, v29, v4
    v_lshlrev_b32 v29, 4, v29
    v_lshl_add_u32 v7, v28, 7, v29
    v_add_u32 v7, 98304, v7
    v_and_b32 v58, 3, v2
    v_lshlrev_b32 v58, 6, v58
    s_mul_i32 s15, s45, 9
    s_add_u32 s15, s15, s46
    s_lshl_b32 s15, s15, 7
    s_lshl_b32 s67, s44, 2
    s_add_u32 s15, s15, s67
    s_add_u32 s15, s15, 147456
    s_mov_b32 s16, 32768
    s_mov_b32 s17, -131072
    s_lshl_b32 s6, s46, 13
    s_mov_b32 s66, s47
    s_add_u32 s7, s66, 0
    s_and_b32 s7, s7, 7
    s_add_u32 s7, s7, s46
    s_add_u32 s7, s7, 1
    s_sub_u32 s67, s7, 9
    s_cmp_ge_u32 s7, 9
    s_cselect_b32 s7, s67, s7
    s_lshl_b32 s7, s7, 13
    s_add_u32 s8, s66, 1
    s_and_b32 s8, s8, 7
    s_add_u32 s8, s8, s46
    s_add_u32 s8, s8, 1
    s_sub_u32 s67, s8, 9
    s_cmp_ge_u32 s8, 9
    s_cselect_b32 s8, s67, s8
    s_lshl_b32 s8, s8, 13
    s_add_u32 s9, s66, 2
    s_and_b32 s9, s9, 7
    s_add_u32 s9, s9, s46
    s_add_u32 s9, s9, 1
    s_sub_u32 s67, s9, 9
    s_cmp_ge_u32 s9, 9
    s_cselect_b32 s9, s67, s9
    s_lshl_b32 s9, s9, 13
    s_add_u32 s10, s66, 3
    s_and_b32 s10, s10, 7
    s_add_u32 s10, s10, s46
    s_add_u32 s10, s10, 1
    s_sub_u32 s67, s10, 9
    s_cmp_ge_u32 s10, 9
    s_cselect_b32 s10, s67, s10
    s_lshl_b32 s10, s10, 13
    s_add_u32 s11, s66, 4
    s_and_b32 s11, s11, 7
    s_add_u32 s11, s11, s46
    s_add_u32 s11, s11, 1
    s_sub_u32 s67, s11, 9
    s_cmp_ge_u32 s11, 9
    s_cselect_b32 s11, s67, s11
    s_lshl_b32 s11, s11, 13
    s_add_u32 s12, s66, 5
    s_and_b32 s12, s12, 7
    s_add_u32 s12, s12, s46
    s_add_u32 s12, s12, 1
    s_sub_u32 s67, s12, 9
    s_cmp_ge_u32 s12, 9
    s_cselect_b32 s12, s67, s12
    s_lshl_b32 s12, s12, 13
    s_add_u32 s13, s66, 6
    s_and_b32 s13, s13, 7
    s_add_u32 s13, s13, s46
    s_add_u32 s13, s13, 1
    s_sub_u32 s67, s13, 9
    s_cmp_ge_u32 s13, 9
    s_cselect_b32 s13, s67, s13
    s_lshl_b32 s13, s13, 13
    s_add_u32 s14, s66, 7
    s_and_b32 s14, s14, 7
    s_add_u32 s14, s14, s46
    s_add_u32 s14, s14, 1
    s_sub_u32 s67, s14, 9
    s_cmp_ge_u32 s14, 9
    s_cselect_b32 s14, s67, s14
    s_lshl_b32 s14, s14, 13
    v_mov_b32 v64, 0
    v_mov_b32 v65, 0
    v_mov_b32 v66, 0
    v_mov_b32 v67, 0
    v_mov_b32 v68, 0
    v_mov_b32 v69, 0
    v_mov_b32 v70, 0
    v_mov_b32 v71, 0
    v_mov_b32 v72, 0
    v_mov_b32 v73, 0
    v_mov_b32 v74, 0
    v_mov_b32 v75, 0
    v_mov_b32 v76, 0
    v_mov_b32 v77, 0
    v_mov_b32 v78, 0
    v_mov_b32 v79, 0
    v_mov_b32 v80, 0
    v_mov_b32 v81, 0
    v_mov_b32 v82, 0
    v_mov_b32 v83, 0
    v_mov_b32 v84, 0
    v_mov_b32 v85, 0
    v_mov_b32 v86, 0
    v_mov_b32 v87, 0
    v_mov_b32 v88, 0
    v_mov_b32 v89, 0
    v_mov_b32 v90, 0
    v_mov_b32 v91, 0
    v_mov_b32 v92, 0
    v_mov_b32 v93, 0
    v_mov_b32 v94, 0
    v_mov_b32 v95, 0
    v_mov_b32 v96, 0
    v_mov_b32 v97, 0
    v_mov_b32 v98, 0
    v_mov_b32 v99, 0
    v_mov_b32 v100, 0
    v_mov_b32 v101, 0
    v_mov_b32 v102, 0
    v_mov_b32 v103, 0
    v_mov_b32 v104, 0
    v_mov_b32 v105, 0
    v_mov_b32 v106, 0
    v_mov_b32 v107, 0
    v_mov_b32 v108, 0
    v_mov_b32 v109, 0
    v_mov_b32 v110, 0
    v_mov_b32 v111, 0
    v_mov_b32 v112, 0
    v_mov_b32 v113, 0
    v_mov_b32 v114, 0
    v_mov_b32 v115, 0
    v_mov_b32 v116, 0
    v_mov_b32 v117, 0
    v_mov_b32 v118, 0
    v_mov_b32 v119, 0
    v_mov_b32 v120, 0
    v_mov_b32 v121, 0
    v_mov_b32 v122, 0
    v_mov_b32 v123, 0
    v_mov_b32 v124, 0
    v_mov_b32 v125, 0
    v_mov_b32 v126, 0
    v_mov_b32 v127, 0
    s_barrier
    ds_read_b128 v[128:131], v8
    ds_read_b128 v[136:139], v12
    ds_read_b128 v[140:143], v12 offset:4096
    ds_read_b128 v[132:135], v8 offset:4096
    ds_read_b128 v[144:147], v9
    ds_read_b128 v[152:155], v13
    ds_read_b128 v[156:159], v13 offset:4096
    ds_read_b128 v[148:151], v9 offset:4096
    s_mov_b32 s66, 0
L_A_g1:
    s_cmp_eq_u32 s66, 4
    s_cselect_b32 s67, s17, s16
    s_waitcnt lgkmcnt(4)
    v_mfma_f32_32x32x16_bf16 v[64:79], v[128:131], v[136:139], v[64:79]
    ds_read_b128 v[160:163], v10
    v_add_u32 v8, s67, v8
    v_add_u32 v12, s67, v12
    v_mfma_f32_32x32x16_bf16 v[96:111], v[128:131], v[140:143], v[96:111]
    ds_read_b128 v[168:171], v14
    v_add_u32 v9, s67, v9
    v_add_u32 v13, s67, v13
    v_mfma_f32_32x32x16_bf16 v[80:95], v[132:135], v[136:139], v[80:95]
    ds_read_b128 v[172:175], v14 offset:4096
    v_mfma_f32_32x32x16_bf16 v[112:127], v[132:135], v[140:143], v[112:127]
    ds_read_b128 v[164:167], v10 offset:4096
    s_waitcnt lgkmcnt(4)
    v_mfma_f32_32x32x16_bf16 v[64:79], v[144:147], v[152:155], v[64:79]
    ds_read_b128 v[176:179], v11
    v_mfma_f32_32x32x16_bf16 v[96:111], v[144:147], v[156:159], v[96:111]
    ds_read_b128 v[184:187], v15
    v_mfma_f32_32x32x16_bf16 v[80:95], v[148:151], v[152:155], v[80:95]
    ds_read_b128 v[188:191], v15 offset:4096
    v_mfma_f32_32x32x16_bf16 v[112:127], v[148:151], v[156:159], v[112:127]
    ds_read_b128 v[180:183], v11 offset:4096
    s_barrier
    s_waitcnt lgkmcnt(4)
    v_mfma_f32_32x32x16_bf16 v[64:79], v[160:163], v[168:171], v[64:79]
    ds_read_b128 v[128:131], v8
    v_add_u32 v10, s67, v10
    v_add_u32 v14, s67, v14
    v_mfma_f32_32x32x16_bf16 v[96:111], v[160:163], v[172:175], v[96:111]
    ds_read_b128 v[136:139], v12
    v_add_u32 v11, s67, v11
    v_add_u32 v15, s67, v15
    v_mfma_f32_32x32x16_bf16 v[80:95], v[164:167], v[168:171], v[80:95]
    ds_read_b128 v[140:143], v12 offset:4096
    v_mfma_f32_32x32x16_bf16 v[112:127], v[164:167], v[172:175], v[112:127]
    ds_read_b128 v[132:135], v8 offset:4096
    s_waitcnt lgkmcnt(4)
    v_mfma_f32_32x32x16_bf16 v[64:79], v[176:179], v[184:187], v[64:79]
    ds_read_b128 v[144:147], v9
    v_mfma_f32_32x32x16_bf16 v[96:111], v[176:179], v[188:191], v[96:111]
    ds_read_b128 v[152:155], v13
    v_mfma_f32_32x32x16_bf16 v[80:95], v[180:183], v[184:187], v[80:95]
    ds_read_b128 v[156:159], v13 offset:4096
    s_add_u32 s66, s66, 1
    v_mfma_f32_32x32x16_bf16 v[112:127], v[180:183], v[188:191], v[112:127]
    ds_read_b128 v[148:151], v9 offset:4096
    s_cmp_lt_u32 s66, 5
    s_cbranch_scc1 L_A_g1
    s_waitcnt vmcnt(0)
    s_mov_b32 s67, s16
    s_waitcnt lgkmcnt(4)
    v_mfma_f32_32x32x16_bf16 v[64:79], v[128:131], v[136:139], v[64:79]
    ds_read_b128 v[160:163], v10
    v_add_u32 v8, s67, v8
    v_add_u32 v12, s67, v12
    v_lshlrev_b32 v24, 16, v24
    v_lshlrev_b32 v25, 16, v25
    v_lshlrev_b32 v26, 16, v26
    v_mul_f32 v26, 0x3fb8aa3b, v26
    v_mfma_f32_32x32x16_bf16 v[96:111], v[128:131], v[140:143], v[96:111]
    ds_read_b128 v[168:171], v14
    v_add_u32 v9, s67, v9
    v_add_u32 v13, s67, v13
    v_exp_f32 v26, v26
    s_nop 0
    v_cvt_pk_bf16_f32 v26, v26, v26
    v_lshlrev_b32 v26, 16, v26
    v_mul_f32 v27, v26, v24
    v_mfma_f32_32x32x16_bf16 v[80:95], v[132:135], v[136:139], v[80:95]
    ds_read_b128 v[172:175], v14 offset:4096
    v_mul_f32 v28, v26, v25
    v_mul_f32 v27, 0x3fb8aa3b, v27
    v_exp_f32 v27, v27
    v_mul_f32 v28, 0.15915494, v28
    v_mfma_f32_32x32x16_bf16 v[112:127], v[132:135], v[140:143], v[112:127]
    ds_read_b128 v[164:167], v10 offset:4096
    v_rndne_f32 v29, v28
    v_sub_f32 v28, v28, v29
    v_cos_f32 v29, v28
    s_waitcnt lgkmcnt(4)
    v_mfma_f32_32x32x16_bf16 v[64:79], v[144:147], v[152:155], v[64:79]
    ds_read_b128 v[176:179], v11
    v_sin_f32 v30, v28
    v_mul_f32 v42, v27, v29
    v_mul_f32 v43, v27, v30
    v_sub_f32 v44, 0, v43
    v_mfma_f32_32x32x16_bf16 v[96:111], v[144:147], v[156:159], v[96:111]
    ds_read_b128 v[184:187], v15
    v_add_f32 v27, -1.0, v42
    v_mul_f32 v28, v24, v24
    v_fmac_f32 v28, v25, v25
    v_rcp_f32 v28, v28
    v_mfma_f32_32x32x16_bf16 v[80:95], v[148:151], v[152:155], v[80:95]
    ds_read_b128 v[188:191], v15 offset:4096
    v_mul_f32 v29, v27, v24
    v_fmac_f32 v29, v43, v25
    v_mul_f32 v30, v43, v24
    v_mfma_f32_32x32x16_bf16 v[112:127], v[148:151], v[156:159], v[112:127]
    ds_read_b128 v[180:183], v11 offset:4096
    v_fma_f32 v30, -v27, v25, v30
    v_add_f32 v28, v28, v28
    v_mul_f32 v46, v29, v28
    v_mul_f32 v47, v30, v28
    s_barrier
    s_waitcnt lgkmcnt(4)
    v_mfma_f32_32x32x16_bf16 v[64:79], v[160:163], v[168:171], v[64:79]
    ds_read_b128 v[128:131], v8
    v_add_u32 v10, s67, v10
    v_add_u32 v14, s67, v14
    v_mul_f32 v28, v42, v42
    v_mul_f32 v29, v42, v43
    v_fma_f32 v28, -v43, v43, v28
    v_fmac_f32 v29, v43, v42
    v_mfma_f32_32x32x16_bf16 v[96:111], v[160:163], v[172:175], v[96:111]
    ds_read_b128 v[136:139], v12
    v_add_u32 v11, s67, v11
    v_add_u32 v15, s67, v15
    v_mul_f32 v30, v28, v28
    v_mul_f32 v31, v28, v29
    v_fma_f32 v30, -v29, v29, v30
    v_mfma_f32_32x32x16_bf16 v[80:95], v[164:167], v[168:171], v[80:95]
    ds_read_b128 v[140:143], v12 offset:4096
    v_fmac_f32 v31, v29, v28
    v_mul_f32 v28, v30, v30
    v_mul_f32 v29, v30, v31
    v_fma_f32 v28, -v31, v31, v28
    v_mfma_f32_32x32x16_bf16 v[112:127], v[164:167], v[172:175], v[112:127]
    ds_read_b128 v[132:135], v8 offset:4096
    v_fmac_f32 v29, v31, v30
    v_mul_f32 v30, v28, v28
    v_mul_f32 v31, v28, v29
    v_fma_f32 v30, -v29, v29, v30
    buffer_load_dword v59, v58, s[72:75], 0 offen sc1
    s_waitcnt lgkmcnt(4)
    v_mfma_f32_32x32x16_bf16 v[64:79], v[176:179], v[184:187], v[64:79]
    ds_read_b128 v[144:147], v9
    v_fmac_f32 v31, v29, v28
    v_mul_f32 v50, v30, v30
    v_mul_f32 v51, v30, v31
    v_mfma_f32_32x32x16_bf16 v[96:111], v[176:179], v[188:191], v[96:111]
    ds_read_b128 v[152:155], v13
    v_fma_f32 v50, -v31, v31, v50
    v_fmac_f32 v51, v31, v30
    v_mul_f32 v52, v50, v50
    v_mul_f32 v53, v50, v51
    v_mfma_f32_32x32x16_bf16 v[80:95], v[180:183], v[184:187], v[80:95]
    ds_read_b128 v[156:159], v13 offset:4096
    v_fma_f32 v52, -v51, v51, v52
    v_fmac_f32 v53, v51, v50
    v_mul_f32 v54, v52, v52
    v_mul_f32 v55, v52, v53
    v_mfma_f32_32x32x16_bf16 v[112:127], v[180:183], v[188:191], v[112:127]
    ds_read_b128 v[148:151], v9 offset:4096
    v_fma_f32 v54, -v53, v53, v54
    v_fmac_f32 v55, v53, v52
    v_mul_f32 v48, v54, v54
    s_mov_b32 s67, s16
    s_waitcnt lgkmcnt(4)
    v_mfma_f32_32x32x16_bf16 v[64:79], v[128:131], v[136:139], v[64:79]
    ds_read_b128 v[160:163], v10
    v_add_u32 v8, s67, v8
    v_add_u32 v12, s67, v12
    v_mul_f32 v49, v54, v55
    v_fma_f32 v48, -v55, v55, v48
    v_fmac_f32 v49, v55, v54
    v_mul_f32 v28, v48, v48
    v_mfma_f32_32x32x16_bf16 v[96:111], v[128:131], v[140:143], v[96:111]
    ds_read_b128 v[168:171], v14
    v_add_u32 v9, s67, v9
    v_add_u32 v13, s67, v13
    v_mul_f32 v29, v48, v49
    v_fma_f32 v28, -v49, v49, v28
    v_fmac_f32 v29, v49, v48
    v_mul_f32 v60, v28, v28
    v_mfma_f32_32x32x16_bf16 v[80:95], v[132:135], v[136:139], v[80:95]
    ds_read_b128 v[172:175], v14 offset:4096
    v_mul_f32 v61, v28, v29
    v_fma_f32 v60, -v29, v29, v60
    v_fmac_f32 v61, v29, v28
    v_mfma_f32_32x32x16_bf16 v[112:127], v[132:135], v[140:143], v[112:127]
    ds_read_b128 v[164:167], v10 offset:4096
    v_mul_f32 v192, v46, v42
    v_mul_f32 v224, v46, v43
    v_fma_f32 v192, -v47, v43, v192
    v_fmac_f32 v224, v47, v42
    s_waitcnt lgkmcnt(4)
    v_mfma_f32_32x32x16_bf16 v[64:79], v[144:147], v[152:155], v[64:79]
    ds_read_b128 v[176:179], v11
    v_mul_f32 v193, v192, v42
    v_mul_f32 v225, v192, v43
    v_fma_f32 v193, -v224, v43, v193
    v_fmac_f32 v225, v224, v42
    v_mfma_f32_32x32x16_bf16 v[96:111], v[144:147], v[156:159], v[96:111]
    ds_read_b128 v[184:187], v15
    v_mul_f32 v194, v193, v42
    v_mul_f32 v226, v193, v43
    v_fma_f32 v194, -v225, v43, v194
    v_mfma_f32_32x32x16_bf16 v[80:95], v[148:151], v[152:155], v[80:95]
    ds_read_b128 v[188:191], v15 offset:4096
    v_fmac_f32 v226, v225, v42
    v_mul_f32 v195, v194, v42
    v_mul_f32 v227, v194, v43
    v_fma_f32 v195, -v226, v43, v195
    v_mfma_f32_32x32x16_bf16 v[112:127], v[148:151], v[156:159], v[112:127]
    ds_read_b128 v[180:183], v11 offset:4096
    v_fmac_f32 v227, v226, v42
    v_mul_f32 v196, v195, v42
    v_mul_f32 v228, v195, v43
    v_fma_f32 v196, -v227, v43, v196
    s_barrier
    s_waitcnt lgkmcnt(4)
    v_mfma_f32_32x32x16_bf16 v[64:79], v[160:163], v[168:171], v[64:79]
    ds_read_b128 v[128:131], v8
    v_add_u32 v10, s67, v10
    v_add_u32 v14, s67, v14
    v_fmac_f32 v228, v227, v42
    v_mul_f32 v197, v196, v42
    v_mul_f32 v229, v196, v43
    v_mfma_f32_32x32x16_bf16 v[96:111], v[160:163], v[172:175], v[96:111]
    ds_read_b128 v[136:139], v12
    v_add_u32 v11, s67, v11
    v_add_u32 v15, s67, v15
    v_fma_f32 v197, -v228, v43, v197
    v_fmac_f32 v229, v228, v42
    v_mul_f32 v198, v197, v42
    v_mul_f32 v230, v197, v43
    v_mfma_f32_32x32x16_bf16 v[80:95], v[164:167], v[168:171], v[80:95]
    ds_read_b128 v[140:143], v12 offset:4096
    v_fma_f32 v198, -v229, v43, v198
    v_fmac_f32 v230, v229, v42
    v_mul_f32 v199, v198, v42
    v_mul_f32 v231, v198, v43
    v_mfma_f32_32x32x16_bf16 v[112:127], v[164:167], v[172:175], v[112:127]
    ds_read_b128 v[132:135], v8 offset:4096
    v_fma_f32 v199, -v230, v43, v199
    v_fmac_f32 v231, v230, v42
    v_mul_f32 v200, v199, v42
    s_waitcnt lgkmcnt(4)
    v_mfma_f32_32x32x16_bf16 v[64:79], v[176:179], v[184:187], v[64:79]
    ds_read_b128 v[144:147], v9
    v_mul_f32 v232, v199, v43
    v_fma_f32 v200, -v231, v43, v200
    v_fmac_f32 v232, v231, v42
    v_mul_f32 v201, v200, v42
    v_mfma_f32_32x32x16_bf16 v[96:111], v[176:179], v[188:191], v[96:111]
    ds_read_b128 v[152:155], v13
    v_mul_f32 v233, v200, v43
    v_fma_f32 v201, -v232, v43, v201
    v_fmac_f32 v233, v232, v42
    v_mul_f32 v202, v201, v42
    v_mfma_f32_32x32x16_bf16 v[80:95], v[180:183], v[184:187], v[80:95]
    ds_read_b128 v[156:159], v13 offset:4096
    v_mul_f32 v234, v201, v43
    v_fma_f32 v202, -v233, v43, v202
    v_fmac_f32 v234, v233, v42
    v_mul_f32 v203, v202, v42
    v_mfma_f32_32x32x16_bf16 v[112:127], v[180:183], v[188:191], v[112:127]
    ds_read_b128 v[148:151], v9 offset:4096
    v_mul_f32 v235, v202, v43
    v_fma_f32 v203, -v234, v43, v203
    v_fmac_f32 v235, v234, v42
    s_mov_b32 s67, s16
    s_waitcnt lgkmcnt(4)
    v_mfma_f32_32x32x16_bf16 v[64:79], v[128:131], v[136:139], v[64:79]
    ds_read_b128 v[160:163], v10
    v_add_u32 v8, s67, v8
    v_add_u32 v12, s67, v12
    v_mul_f32 v204, v203, v42
    v_mul_f32 v236, v203, v43
    v_fma_f32 v204, -v235, v43, v204
    v_fmac_f32 v236, v235, v42
    v_mfma_f32_32x32x16_bf16 v[96:111], v[128:131], v[140:143], v[96:111]
    ds_read_b128 v[168:171], v14
    v_add_u32 v9, s67, v9
    v_add_u32 v13, s67, v13
    v_mul_f32 v205, v204, v42
    v_mul_f32 v237, v204, v43
    v_fma_f32 v205, -v236, v43, v205
    v_fmac_f32 v237, v236, v42
    v_mfma_f32_32x32x16_bf16 v[80:95], v[132:135], v[136:139], v[80:95]
    ds_read_b128 v[172:175], v14 offset:4096
    v_mul_f32 v206, v205, v42
    v_mul_f32 v238, v205, v43
    v_fma_f32 v206, -v237, v43, v206
    v_mfma_f32_32x32x16_bf16 v[112:127], v[132:135], v[140:143], v[112:127]
    ds_read_b128 v[164:167], v10 offset:4096
    v_fmac_f32 v238, v237, v42
    v_mul_f32 v207, v206, v42
    v_mul_f32 v239, v206, v43
    v_fma_f32 v207, -v238, v43, v207
    s_waitcnt lgkmcnt(4)
    v_mfma_f32_32x32x16_bf16 v[64:79], v[144:147], v[152:155], v[64:79]
    ds_read_b128 v[176:179], v11
    v_fmac_f32 v239, v238, v42
    v_mul_f32 v208, v207, v42
    v_mul_f32 v240, v207, v43
    v_fma_f32 v208, -v239, v43, v208
    v_mfma_f32_32x32x16_bf16 v[96:111], v[144:147], v[156:159], v[96:111]
    ds_read_b128 v[184:187], v15
    v_fmac_f32 v240, v239, v42
    v_mul_f32 v209, v208, v42
    v_mul_f32 v241, v208, v43
    v_mfma_f32_32x32x16_bf16 v[80:95], v[148:151], v[152:155], v[80:95]
    ds_read_b128 v[188:191], v15 offset:4096
    v_fma_f32 v209, -v240, v43, v209
    v_fmac_f32 v241, v240, v42
    v_mul_f32 v210, v209, v42
    v_mul_f32 v242, v209, v43
    v_mfma_f32_32x32x16_bf16 v[112:127], v[148:151], v[156:159], v[112:127]
    ds_read_b128 v[180:183], v11 offset:4096
    v_fma_f32 v210, -v241, v43, v210
    v_fmac_f32 v242, v241, v42
    v_mul_f32 v211, v210, v42
    v_mul_f32 v243, v210, v43
    s_barrier
    s_waitcnt lgkmcnt(4)
    v_mfma_f32_32x32x16_bf16 v[64:79], v[160:163], v[168:171], v[64:79]
    ds_read_b128 v[128:131], v8
    v_add_u32 v10, s67, v10
    v_add_u32 v14, s67, v14
    v_fma_f32 v211, -v242, v43, v211
    v_fmac_f32 v243, v242, v42
    v_mul_f32 v212, v211, v42
    v_mfma_f32_32x32x16_bf16 v[96:111], v[160:163], v[172:175], v[96:111]
    ds_read_b128 v[136:139], v12
    v_add_u32 v11, s67, v11
    v_add_u32 v15, s67, v15
    v_mul_f32 v244, v211, v43
    v_fma_f32 v212, -v243, v43, v212
    v_fmac_f32 v244, v243, v42
    v_mul_f32 v213, v212, v42
    v_mfma_f32_32x32x16_bf16 v[80:95], v[164:167], v[168:171], v[80:95]
    ds_read_b128 v[140:143], v12 offset:4096
    v_mul_f32 v245, v212, v43
    v_fma_f32 v213, -v244, v43, v213
    v_fmac_f32 v245, v244, v42
    v_mul_f32 v214, v213, v42
    v_mfma_f32_32x32x16_bf16 v[112:127], v[164:167], v[172:175], v[112:127]
    ds_read_b128 v[132:135], v8 offset:4096
    v_mul_f32 v246, v213, v43
    v_fma_f32 v214, -v245, v43, v214
    v_fmac_f32 v246, v245, v42
    s_waitcnt lgkmcnt(4)
    v_mfma_f32_32x32x16_bf16 v[64:79], v[176:179], v[184:187], v[64:79]
    ds_read_b128 v[144:147], v9
    v_mul_f32 v215, v214, v42
    v_mul_f32 v247, v214, v43
    v_fma_f32 v215, -v246, v43, v215
    v_fmac_f32 v247, v246, v42
    v_mfma_f32_32x32x16_bf16 v[96:111], v[176:179], v[188:191], v[96:111]
    ds_read_b128 v[152:155], v13
    v_mul_f32 v216, v215, v42
    v_mul_f32 v248, v215, v43
    v_fma_f32 v216, -v247, v43, v216
    v_fmac_f32 v248, v247, v42
    v_mfma_f32_32x32x16_bf16 v[80:95], v[180:183], v[184:187], v[80:95]
    ds_read_b128 v[156:159], v13 offset:4096
    v_mul_f32 v217, v216, v42
    v_mul_f32 v249, v216, v43
    v_fma_f32 v217, -v248, v43, v217
    v_mfma_f32_32x32x16_bf16 v[112:127], v[180:183], v[188:191], v[112:127]
    ds_read_b128 v[148:151], v9 offset:4096
    v_fmac_f32 v249, v248, v42
    v_mul_f32 v218, v217, v42
    v_mul_f32 v250, v217, v43
    v_fma_f32 v218, -v249, v43, v218
    s_waitcnt lgkmcnt(4)
    v_mfma_f32_32x32x16_bf16 v[64:79], v[128:131], v[136:139], v[64:79]
    ds_read_b128 v[160:163], v10
    v_fmac_f32 v250, v249, v42
    v_mul_f32 v219, v218, v42
    v_mul_f32 v251, v218, v43
    v_fma_f32 v219, -v250, v43, v219
    v_mfma_f32_32x32x16_bf16 v[96:111], v[128:131], v[140:143], v[96:111]
    ds_read_b128 v[168:171], v14
    v_fmac_f32 v251, v250, v42
    v_mul_f32 v220, v219, v42
    v_mul_f32 v252, v219, v43
    v_mfma_f32_32x32x16_bf16 v[80:95], v[132:135], v[136:139], v[80:95]
    ds_read_b128 v[172:175], v14 offset:4096
    v_fma_f32 v220, -v251, v43, v220
    v_fmac_f32 v252, v251, v42
    v_mul_f32 v221, v220, v42
    v_mul_f32 v253, v220, v43
    v_mfma_f32_32x32x16_bf16 v[112:127], v[132:135], v[140:143], v[112:127]
    ds_read_b128 v[164:167], v10 offset:4096
    v_fma_f32 v221, -v252, v43, v221
    v_fmac_f32 v253, v252, v42
    v_mul_f32 v222, v221, v42
    v_mul_f32 v254, v221, v43
    s_waitcnt lgkmcnt(4)
    v_mfma_f32_32x32x16_bf16 v[64:79], v[144:147], v[152:155], v[64:79]
    ds_read_b128 v[176:179], v11
    v_fma_f32 v222, -v253, v43, v222
    v_fmac_f32 v254, v253, v42
    v_mul_f32 v223, v222, v42
    v_mfma_f32_32x32x16_bf16 v[96:111], v[144:147], v[156:159], v[96:111]
    ds_read_b128 v[184:187], v15
    v_mul_f32 v255, v222, v43
    v_fma_f32 v223, -v254, v43, v223
    v_fmac_f32 v255, v254, v42
    s_mov_b32 s52, s20
    v_mfma_f32_32x32x16_bf16 v[80:95], v[148:151], v[152:155], v[80:95]
    ds_read_b128 v[188:191], v15 offset:4096
    s_mov_b32 s53, s21
    s_mov_b32 s54, 0x480
    s_mov_b32 s55, 0x20000
    s_mov_b32 s56, s36
    v_mfma_f32_32x32x16_bf16 v[112:127], v[148:151], v[156:159], v[112:127]
    ds_read_b128 v[180:183], v11 offset:4096
    s_mov_b32 s57, s37
    s_mov_b32 s58, 0x900000
    s_mov_b32 s59, 0x20000
    s_mov_b32 s66, 200000
L_A_clr:
    s_waitcnt vmcnt(0)
    v_cmp_gt_u32 vcc, 8, v59
    s_nop 0
    s_cmp_eq_u64 vcc, 0
    s_cbranch_scc1 L_A_clr_ok
    buffer_load_dword v59, v58, s[72:75], 0 offen sc1
    s_sub_u32 s66, s66, 1
    s_cmp_eq_u32 s66, 0
    s_cbranch_scc0 L_A_clr
L_A_clr_ok:
    s_waitcnt lgkmcnt(4)
    v_mfma_f32_32x32x16_bf16 v[64:79], v[160:163], v[168:171], v[64:79]
    v_mov_b32 v31, v41
    buffer_load_dwordx4 v[128:131], v31, s[60:63], 0 offen sc1
    v_mfma_f32_32x32x16_bf16 v[96:111], v[160:163], v[172:175], v[96:111]
    v_subrev_u32 v31, 18432, v31
    buffer_load_dwordx4 v[132:135], v31, s[60:63], 0 offen sc1
    v_mfma_f32_32x32x16_bf16 v[80:95], v[164:167], v[168:171], v[80:95]
    v_subrev_u32 v31, 18432, v31
    buffer_load_dwordx4 v[136:139], v31, s[60:63], 0 offen sc1
    v_mfma_f32_32x32x16_bf16 v[112:127], v[164:167], v[172:175], v[112:127]
    v_subrev_u32 v31, 18432, v31
    buffer_load_dwordx4 v[140:143], v31, s[60:63], 0 offen sc1
    s_waitcnt lgkmcnt(0)
    v_mfma_f32_32x32x16_bf16 v[64:79], v[176:179], v[184:187], v[64:79]
    v_subrev_u32 v31, 18432, v31
    buffer_load_dwordx4 v[144:147], v31, s[60:63], 0 offen sc1
    v_mfma_f32_32x32x16_bf16 v[96:111], v[176:179], v[188:191], v[96:111]
    v_subrev_u32 v31, 18432, v31
    buffer_load_dwordx4 v[148:151], v31, s[60:63], 0 offen sc1
    v_mfma_f32_32x32x16_bf16 v[80:95], v[180:183], v[184:187], v[80:95]
    v_subrev_u32 v31, 18432, v31
    buffer_load_dwordx4 v[152:155], v31, s[60:63], 0 offen sc1
    v_mfma_f32_32x32x16_bf16 v[112:127], v[180:183], v[188:191], v[112:127]
    v_subrev_u32 v31, 18432, v31
    buffer_load_dwordx4 v[156:159], v31, s[60:63], 0 offen sc1
    s_nop 0
    v_fmac_f32 v65, v42, v64
    s_nop 1
    v_fmac_f32 v97, v42, v96
    v_fmac_f32 v65, v44, v96
    v_fmac_f32 v97, v43, v64
    v_fmac_f32 v66, v42, v65
    v_fmac_f32 v98, v42, v97
    v_fmac_f32 v66, v44, v97
    v_fmac_f32 v98, v43, v65
    v_fmac_f32 v67, v42, v66
    v_fmac_f32 v99, v42, v98
    v_fmac_f32 v67, v44, v98
    v_fmac_f32 v99, v43, v66
    v_fmac_f32 v68, v42, v67
    v_fmac_f32 v100, v42, v99
    v_fmac_f32 v68, v44, v99
    v_fmac_f32 v100, v43, v67
    v_fmac_f32 v69, v42, v68
    v_fmac_f32 v101, v42, v100
    v_fmac_f32 v69, v44, v100
    v_fmac_f32 v101, v43, v68
    v_fmac_f32 v70, v42, v69
    v_fmac_f32 v102, v42, v101
    v_fmac_f32 v70, v44, v101
    v_fmac_f32 v102, v43, v69
    v_fmac_f32 v71, v42, v70
    v_fmac_f32 v103, v42, v102
    v_fmac_f32 v71, v44, v102
    v_fmac_f32 v103, v43, v70
    v_fmac_f32 v72, v42, v71
    v_fmac_f32 v104, v42, v103
    v_fmac_f32 v72, v44, v103
    v_fmac_f32 v104, v43, v71
    v_fmac_f32 v73, v42, v72
    v_fmac_f32 v105, v42, v104
    v_fmac_f32 v73, v44, v104
    v_fmac_f32 v105, v43, v72
    v_fmac_f32 v74, v42, v73
    v_fmac_f32 v106, v42, v105
    v_fmac_f32 v74, v44, v105
    v_fmac_f32 v106, v43, v73
    v_fmac_f32 v75, v42, v74
    v_fmac_f32 v107, v42, v106
    v_fmac_f32 v75, v44, v106
    v_fmac_f32 v107, v43, v74
    v_fmac_f32 v76, v42, v75
    v_fmac_f32 v108, v42, v107
    v_fmac_f32 v76, v44, v107
    v_fmac_f32 v108, v43, v75
    v_fmac_f32 v77, v42, v76
    v_fmac_f32 v109, v42, v108
    v_fmac_f32 v77, v44, v108
    v_fmac_f32 v109, v43, v76
    v_fmac_f32 v78, v42, v77
    v_fmac_f32 v110, v42, v109
    v_fmac_f32 v78, v44, v109
    v_fmac_f32 v110, v43, v77
    v_fmac_f32 v79, v42, v78
    v_fmac_f32 v111, v42, v110
    v_fmac_f32 v79, v44, v110
    v_fmac_f32 v111, v43, v78
    v_fmac_f32 v80, v42, v79
    v_fmac_f32 v112, v42, v111
    v_fmac_f32 v80, v44, v111
    v_fmac_f32 v112, v43, v79
    v_fmac_f32 v81, v42, v80
    v_fmac_f32 v113, v42, v112
    v_fmac_f32 v81, v44, v112
    v_fmac_f32 v113, v43, v80
    v_fmac_f32 v82, v42, v81
    v_fmac_f32 v114, v42, v113
    v_fmac_f32 v82, v44, v113
    v_fmac_f32 v114, v43, v81
    v_fmac_f32 v83, v42, v82
    v_fmac_f32 v115, v42, v114
    v_fmac_f32 v83, v44, v114
    v_fmac_f32 v115, v43, v82
    v_fmac_f32 v84, v42, v83
    v_fmac_f32 v116, v42, v115
    v_fmac_f32 v84, v44, v115
    v_fmac_f32 v116, v43, v83
    v_fmac_f32 v85, v42, v84
    v_fmac_f32 v117, v42, v116
    v_fmac_f32 v85, v44, v116
    v_fmac_f32 v117, v43, v84
    v_fmac_f32 v86, v42, v85
    v_fmac_f32 v118, v42, v117
    v_fmac_f32 v86, v44, v117
    v_fmac_f32 v118, v43, v85
    v_fmac_f32 v87, v42, v86
    v_fmac_f32 v119, v42, v118
    v_fmac_f32 v87, v44, v118
    v_fmac_f32 v119, v43, v86
    v_fmac_f32 v88, v42, v87
    v_fmac_f32 v120, v42, v119
    v_fmac_f32 v88, v44, v119
    v_fmac_f32 v120, v43, v87
    v_fmac_f32 v89, v42, v88
    v_fmac_f32 v121, v42, v120
    v_fmac_f32 v89, v44, v120
    v_fmac_f32 v121, v43, v88
    v_fmac_f32 v90, v42, v89
    v_fmac_f32 v122, v42, v121
    v_fmac_f32 v90, v44, v121
    v_fmac_f32 v122, v43, v89
    v_fmac_f32 v91, v42, v90
    v_fmac_f32 v123, v42, v122
    v_fmac_f32 v91, v44, v122
    v_fmac_f32 v123, v43, v90
    v_fmac_f32 v92, v42, v91
    v_fmac_f32 v124, v42, v123
    v_fmac_f32 v92, v44, v123
    v_fmac_f32 v124, v43, v91
    v_fmac_f32 v93, v42, v92
    v_fmac_f32 v125, v42, v124
    v_fmac_f32 v93, v44, v124
    v_fmac_f32 v125, v43, v92
    v_fmac_f32 v94, v42, v93
    v_fmac_f32 v126, v42, v125
    v_fmac_f32 v94, v44, v125
    v_fmac_f32 v126, v43, v93
    v_fmac_f32 v95, v42, v94
    v_fmac_f32 v127, v42, v126
    v_fmac_f32 v95, v44, v126
    v_fmac_f32 v127, v43, v94
    v_mov_b32 v56, v95
    v_mov_b32 v58, v95
    v_mov_b32 v57, v127
    v_mov_b32 v59, v127
    v_permlane32_swap_b32 v56, v58
    s_nop 0
    v_permlane32_swap_b32 v57, v59
    v_fmac_f32 v58, v50, v56
    v_fmac_f32 v59, v50, v57
    v_fma_f32 v58, -v51, v57, v58
    v_fmac_f32 v59, v51, v56
    v_min_u32 v58, -2, v58
    v_min_u32 v59, -2, v59
    s_mov_b32 exec_hi, 0
    buffer_store_dwordx2 v[58:59], v36, s[60:63], 0 offen sc1
    s_mov_b64 exec, -1
    s_cmp_eq_u32 s68, 0
    s_cbranch_scc0 L_A_now
    ds_write_b64 v37, v[58:59]
L_A_now:
    v_xor_b32 v30, 0, v7
    ds_read_b128 v[160:163], v30
    buffer_load_dwordx4 v[176:179], v6, s[52:55], 0 offen offset:0
    v_xor_b32 v30, 32, v7
    ds_read_b128 v[164:167], v30
    buffer_load_dwordx4 v[180:183], v6, s[52:55], 0 offen offset:32
    v_xor_b32 v30, 64, v7
    ds_read_b128 v[168:171], v30
    buffer_load_dwordx4 v[184:187], v6, s[52:55], 0 offen offset:64
    v_xor_b32 v30, 96, v7
    ds_read_b128 v[172:175], v30
    buffer_load_dwordx4 v[188:191], v6, s[52:55], 0 offen offset:96
    s_waitcnt vmcnt(5)
    v_max_u32 v30, v128, v129
    v_max_u32 v31, v130, v131
    v_max3_u32 v30, v30, v132, v133
    v_max3_u32 v31, v31, v134, v135
    v_max3_u32 v30, v30, v136, v137
    v_max3_u32 v31, v31, v138, v139
    v_max3_u32 v30, v30, v140, v141
    v_max3_u32 v31, v31, v142, v143
    v_max3_u32 v30, v30, v144, v145
    v_max3_u32 v31, v31, v146, v147
    v_max3_u32 v30, v30, v148, v149
    v_max3_u32 v31, v31, v150, v151
    v_max3_u32 v30, v30, v152, v153
    v_max3_u32 v31, v31, v154, v155
    v_max3_u32 v30, v30, v156, v157
    v_max3_u32 v31, v31, v158, v159
    v_max_u32 v30, v30, v31
    v_cmp_eq_u32 vcc, -1, v30
    s_nop 0
    s_cmp_eq_u64 vcc, 0
    s_cbranch_scc1 L_A_noreg
    v_mov_b32 v31, v41
    buffer_load_dwordx4 v[128:131], v31, s[60:63], 0 offen sc1
    v_subrev_u32 v31, 18432, v31
    buffer_load_dwordx4 v[132:135], v31, s[60:63], 0 offen sc1
    v_subrev_u32 v31, 18432, v31
    buffer_load_dwordx4 v[136:139], v31, s[60:63], 0 offen sc1
    v_subrev_u32 v31, 18432, v31
    buffer_load_dwordx4 v[140:143], v31, s[60:63], 0 offen sc1
    v_subrev_u32 v31, 18432, v31
    buffer_load_dwordx4 v[144:147], v31, s[60:63], 0 offen sc1
    v_subrev_u32 v31, 18432, v31
    buffer_load_dwordx4 v[148:151], v31, s[60:63], 0 offen sc1
    v_subrev_u32 v31, 18432, v31
    buffer_load_dwordx4 v[152:155], v31, s[60:63], 0 offen sc1
    v_subrev_u32 v31, 18432, v31
    buffer_load_dwordx4 v[156:159], v31, s[60:63], 0 offen sc1
L_A_noreg:
    s_waitcnt lgkmcnt(0)
    s_barrier
    ds_read_b64 v[28:29], v37
    v_pk_mul_f32 v[62:63], v[64:65], v[46:47] op_sel:[0,0] op_sel_hi:[1,0]
    v_pk_fma_f32 v[62:63], v[96:97], v[46:47], v[62:63] op_sel:[0,1,0] op_sel_hi:[1,1,1] neg_lo:[1,0,0] neg_hi:[1,0,0]
    v_pk_mul_f32 v[96:97], v[96:97], v[46:47] op_sel:[0,0] op_sel_hi:[1,0] neg_lo:[1,0] neg_hi:[1,0]
    v_pk_fma_f32 v[96:97], v[64:65], v[46:47], v[96:97] op_sel:[0,1,0] op_sel_hi:[1,1,1] neg_lo:[1,0,0] neg_hi:[1,0,0]
    v_pk_mul_f32 v[64:65], v[66:67], v[46:47] op_sel:[0,0] op_sel_hi:[1,0]
    v_pk_fma_f32 v[64:65], v[98:99], v[46:47], v[64:65] op_sel:[0,1,0] op_sel_hi:[1,1,1] neg_lo:[1,0,0] neg_hi:[1,0,0]
    v_pk_mul_f32 v[98:99], v[98:99], v[46:47] op_sel:[0,0] op_sel_hi:[1,0] neg_lo:[1,0] neg_hi:[1,0]
    v_pk_fma_f32 v[98:99], v[66:67], v[46:47], v[98:99] op_sel:[0,1,0] op_sel_hi:[1,1,1] neg_lo:[1,0,0] neg_hi:[1,0,0]
    v_pk_mul_f32 v[66:67], v[68:69], v[46:47] op_sel:[0,0] op_sel_hi:[1,0]
    v_pk_fma_f32 v[66:67], v[100:101], v[46:47], v[66:67] op_sel:[0,1,0] op_sel_hi:[1,1,1] neg_lo:[1,0,0] neg_hi:[1,0,0]
    v_pk_mul_f32 v[100:101], v[100:101], v[46:47] op_sel:[0,0] op_sel_hi:[1,0] neg_lo:[1,0] neg_hi:[1,0]
    v_pk_fma_f32 v[100:101], v[68:69], v[46:47], v[100:101] op_sel:[0,1,0] op_sel_hi:[1,1,1] neg_lo:[1,0,0] neg_hi:[1,0,0]
    v_pk_mul_f32 v[68:69], v[70:71], v[46:47] op_sel:[0,0] op_sel_hi:[1,0]
    v_pk_fma_f32 v[68:69], v[102:103], v[46:47], v[68:69] op_sel:[0,1,0] op_sel_hi:[1,1,1] neg_lo:[1,0,0] neg_hi:[1,0,0]
    v_pk_mul_f32 v[102:103], v[102:103], v[46:47] op_sel:[0,0] op_sel_hi:[1,0] neg_lo:[1,0] neg_hi:[1,0]
    v_pk_fma_f32 v[102:103], v[70:71], v[46:47], v[102:103] op_sel:[0,1,0] op_sel_hi:[1,1,1] neg_lo:[1,0,0] neg_hi:[1,0,0]
    v_pk_mul_f32 v[70:71], v[72:73], v[46:47] op_sel:[0,0] op_sel_hi:[1,0]
    v_pk_fma_f32 v[70:71], v[104:105], v[46:47], v[70:71] op_sel:[0,1,0] op_sel_hi:[1,1,1] neg_lo:[1,0,0] neg_hi:[1,0,0]
    v_pk_mul_f32 v[104:105], v[104:105], v[46:47] op_sel:[0,0] op_sel_hi:[1,0] neg_lo:[1,0] neg_hi:[1,0]
    v_pk_fma_f32 v[104:105], v[72:73], v[46:47], v[104:105] op_sel:[0,1,0] op_sel_hi:[1,1,1] neg_lo:[1,0,0] neg_hi:[1,0,0]
    v_pk_mul_f32 v[72:73], v[74:75], v[46:47] op_sel:[0,0] op_sel_hi:[1,0]
    v_pk_fma_f32 v[72:73], v[106:107], v[46:47], v[72:73] op_sel:[0,1,0] op_sel_hi:[1,1,1] neg_lo:[1,0,0] neg_hi:[1,0,0]
    v_pk_mul_f32 v[106:107], v[106:107], v[46:47] op_sel:[0,0] op_sel_hi:[1,0] neg_lo:[1,0] neg_hi:[1,0]
    v_pk_fma_f32 v[106:107], v[74:75], v[46:47], v[106:107] op_sel:[0,1,0] op_sel_hi:[1,1,1] neg_lo:[1,0,0] neg_hi:[1,0,0]
    v_pk_mul_f32 v[74:75], v[76:77], v[46:47] op_sel:[0,0] op_sel_hi:[1,0]
    v_pk_fma_f32 v[74:75], v[108:109], v[46:47], v[74:75] op_sel:[0,1,0] op_sel_hi:[1,1,1] neg_lo:[1,0,0] neg_hi:[1,0,0]
    v_pk_mul_f32 v[108:109], v[108:109], v[46:47] op_sel:[0,0] op_sel_hi:[1,0] neg_lo:[1,0] neg_hi:[1,0]
    v_pk_fma_f32 v[108:109], v[76:77], v[46:47], v[108:109] op_sel:[0,1,0] op_sel_hi:[1,1,1] neg_lo:[1,0,0] neg_hi:[1,0,0]
    v_pk_mul_f32 v[76:77], v[78:79], v[46:47] op_sel:[0,0] op_sel_hi:[1,0]
    v_pk_fma_f32 v[76:77], v[110:111], v[46:47], v[76:77] op_sel:[0,1,0] op_sel_hi:[1,1,1] neg_lo:[1,0,0] neg_hi:[1,0,0]
    v_pk_mul_f32 v[110:111], v[110:111], v[46:47] op_sel:[0,0] op_sel_hi:[1,0] neg_lo:[1,0] neg_hi:[1,0]
    v_pk_fma_f32 v[110:111], v[78:79], v[46:47], v[110:111] op_sel:[0,1,0] op_sel_hi:[1,1,1] neg_lo:[1,0,0] neg_hi:[1,0,0]
    v_pk_mul_f32 v[78:79], v[80:81], v[46:47] op_sel:[0,0] op_sel_hi:[1,0]
    v_pk_fma_f32 v[78:79], v[112:113], v[46:47], v[78:79] op_sel:[0,1,0] op_sel_hi:[1,1,1] neg_lo:[1,0,0] neg_hi:[1,0,0]
    v_pk_mul_f32 v[112:113], v[112:113], v[46:47] op_sel:[0,0] op_sel_hi:[1,0] neg_lo:[1,0] neg_hi:[1,0]
    v_pk_fma_f32 v[112:113], v[80:81], v[46:47], v[112:113] op_sel:[0,1,0] op_sel_hi:[1,1,1] neg_lo:[1,0,0] neg_hi:[1,0,0]
    v_pk_mul_f32 v[80:81], v[82:83], v[46:47] op_sel:[0,0] op_sel_hi:[1,0]
    v_pk_fma_f32 v[80:81], v[114:115], v[46:47], v[80:81] op_sel:[0,1,0] op_sel_hi:[1,1,1] neg_lo:[1,0,0] neg_hi:[1,0,0]
    v_pk_mul_f32 v[114:115], v[114:115], v[46:47] op_sel:[0,0] op_sel_hi:[1,0] neg_lo:[1,0] neg_hi:[1,0]
    v_pk_fma_f32 v[114:115], v[82:83], v[46:47], v[114:115] op_sel:[0,1,0] op_sel_hi:[1,1,1] neg_lo:[1,0,0] neg_hi:[1,0,0]
    v_pk_mul_f32 v[82:83], v[84:85], v[46:47] op_sel:[0,0] op_sel_hi:[1,0]
    v_pk_fma_f32 v[82:83], v[116:117], v[46:47], v[82:83] op_sel:[0,1,0] op_sel_hi:[1,1,1] neg_lo:[1,0,0] neg_hi:[1,0,0]
    v_pk_mul_f32 v[116:117], v[116:117], v[46:47] op_sel:[0,0] op_sel_hi:[1,0] neg_lo:[1,0] neg_hi:[1,0]
    v_pk_fma_f32 v[116:117], v[84:85], v[46:47], v[116:117] op_sel:[0,1,0] op_sel_hi:[1,1,1] neg_lo:[1,0,0] neg_hi:[1,0,0]
    v_pk_mul_f32 v[84:85], v[86:87], v[46:47] op_sel:[0,0] op_sel_hi:[1,0]
    v_pk_fma_f32 v[84:85], v[118:119], v[46:47], v[84:85] op_sel:[0,1,0] op_sel_hi:[1,1,1] neg_lo:[1,0,0] neg_hi:[1,0,0]
    v_pk_mul_f32 v[118:119], v[118:119], v[46:47] op_sel:[0,0] op_sel_hi:[1,0] neg_lo:[1,0] neg_hi:[1,0]
    v_pk_fma_f32 v[118:119], v[86:87], v[46:47], v[118:119] op_sel:[0,1,0] op_sel_hi:[1,1,1] neg_lo:[1,0,0] neg_hi:[1,0,0]
    v_pk_mul_f32 v[86:87], v[88:89], v[46:47] op_sel:[0,0] op_sel_hi:[1,0]
    v_pk_fma_f32 v[86:87], v[120:121], v[46:47], v[86:87] op_sel:[0,1,0] op_sel_hi:[1,1,1] neg_lo:[1,0,0] neg_hi:[1,0,0]
    v_pk_mul_f32 v[120:121], v[120:121], v[46:47] op_sel:[0,0] op_sel_hi:[1,0] neg_lo:[1,0] neg_hi:[1,0]
    v_pk_fma_f32 v[120:121], v[88:89], v[46:47], v[120:121] op_sel:[0,1,0] op_sel_hi:[1,1,1] neg_lo:[1,0,0] neg_hi:[1,0,0]
    v_pk_mul_f32 v[88:89], v[90:91], v[46:47] op_sel:[0,0] op_sel_hi:[1,0]
    v_pk_fma_f32 v[88:89], v[122:123], v[46:47], v[88:89] op_sel:[0,1,0] op_sel_hi:[1,1,1] neg_lo:[1,0,0] neg_hi:[1,0,0]
    v_pk_mul_f32 v[122:123], v[122:123], v[46:47] op_sel:[0,0] op_sel_hi:[1,0] neg_lo:[1,0] neg_hi:[1,0]
    v_pk_fma_f32 v[122:123], v[90:91], v[46:47], v[122:123] op_sel:[0,1,0] op_sel_hi:[1,1,1] neg_lo:[1,0,0] neg_hi:[1,0,0]
    v_pk_mul_f32 v[90:91], v[92:93], v[46:47] op_sel:[0,0] op_sel_hi:[1,0]
    v_pk_fma_f32 v[90:91], v[124:125], v[46:47], v[90:91] op_sel:[0,1,0] op_sel_hi:[1,1,1] neg_lo:[1,0,0] neg_hi:[1,0,0]
    v_pk_mul_f32 v[124:125], v[124:125], v[46:47] op_sel:[0,0] op_sel_hi:[1,0] neg_lo:[1,0] neg_hi:[1,0]
    v_pk_fma_f32 v[124:125], v[92:93], v[46:47], v[124:125] op_sel:[0,1,0] op_sel_hi:[1,1,1] neg_lo:[1,0,0] neg_hi:[1,0,0]
    v_pk_mul_f32 v[92:93], v[94:95], v[46:47] op_sel:[0,0] op_sel_hi:[1,0]
    v_pk_fma_f32 v[92:93], v[126:127], v[46:47], v[92:93] op_sel:[0,1,0] op_sel_hi:[1,1,1] neg_lo:[1,0,0] neg_hi:[1,0,0]
    v_pk_mul_f32 v[126:127], v[126:127], v[46:47] op_sel:[0,0] op_sel_hi:[1,0] neg_lo:[1,0] neg_hi:[1,0]
    v_pk_fma_f32 v[126:127], v[94:95], v[46:47], v[126:127] op_sel:[0,1,0] op_sel_hi:[1,1,1] neg_lo:[1,0,0] neg_hi:[1,0,0]
    s_mov_b32 s66, 200000
    s_waitcnt vmcnt(0)
L_A_pollE:
    v_max_u32 v30, v128, v129
    v_max_u32 v31, v130, v131
    v_max3_u32 v30, v30, v132, v133
    v_max3_u32 v31, v31, v134, v135
    v_max3_u32 v30, v30, v136, v137
    v_max3_u32 v31, v31, v138, v139
    v_max3_u32 v30, v30, v140, v141
    v_max3_u32 v31, v31, v142, v143
    v_max3_u32 v30, v30, v144, v145
    v_max3_u32 v31, v31, v146, v147
    v_max3_u32 v30, v30, v148, v149
    v_max3_u32 v31, v31, v150, v151
    v_max3_u32 v30, v30, v152, v153
    v_max3_u32 v31, v31, v154, v155
    v_max3_u32 v30, v30, v156, v157
    v_max3_u32 v31, v31, v158, v159
    v_max_u32 v30, v30, v31
    v_cmp_eq_u32 vcc, -1, v30
    s_nop 0
    s_cmp_eq_u64 vcc, 0
    s_cbranch_scc1 L_A_E_ok
    v_mov_b32 v31, v41
    buffer_load_dwordx4 v[128:131], v31, s[60:63], 0 offen sc1
    v_subrev_u32 v31, 18432, v31
    buffer_load_dwordx4 v[132:135], v31, s[60:63], 0 offen sc1
    v_subrev_u32 v31, 18432, v31
    buffer_load_dwordx4 v[136:139], v31, s[60:63], 0 offen sc1
    v_subrev_u32 v31, 18432, v31
    buffer_load_dwordx4 v[140:143], v31, s[60:63], 0 offen sc1
    v_subrev_u32 v31, 18432, v31
    buffer_load_dwordx4 v[144:147], v31, s[60:63], 0 offen sc1
    v_subrev_u32 v31, 18432, v31
    buffer_load_dwordx4 v[148:151], v31, s[60:63], 0 offen sc1
    v_subrev_u32 v31, 18432, v31
    buffer_load_dwordx4 v[152:155], v31, s[60:63], 0 offen sc1
    v_subrev_u32 v31, 18432, v31
    buffer_load_dwordx4 v[156:159], v31, s[60:63], 0 offen sc1
    s_sub_u32 s66, s66, 1
    s_cmp_eq_u32 s66, 0
    s_waitcnt vmcnt(0)
    s_cbranch_scc0 L_A_pollE
L_A_E_ok:
    v_pk_fma_f32 v[130:131], v[128:129], v[52:53], v[130:131] op_sel:[0,0,0] op_sel_hi:[0,1,1]
    v_pk_fma_f32 v[134:135], v[132:133], v[52:53], v[134:135] op_sel:[0,0,0] op_sel_hi:[0,1,1]
    v_pk_fma_f32 v[138:139], v[136:137], v[52:53], v[138:139] op_sel:[0,0,0] op_sel_hi:[0,1,1]
    v_pk_fma_f32 v[142:143], v[140:141], v[52:53], v[142:143] op_sel:[0,0,0] op_sel_hi:[0,1,1]
    v_pk_fma_f32 v[146:147], v[144:145], v[52:53], v[146:147] op_sel:[0,0,0] op_sel_hi:[0,1,1]
    v_pk_fma_f32 v[150:151], v[148:149], v[52:53], v[150:151] op_sel:[0,0,0] op_sel_hi:[0,1,1]
    v_pk_fma_f32 v[154:155], v[152:153], v[52:53], v[154:155] op_sel:[0,0,0] op_sel_hi:[0,1,1]
    v_pk_fma_f32 v[158:159], v[156:157], v[52:53], v[158:159] op_sel:[0,0,0] op_sel_hi:[0,1,1]
    v_pk_fma_f32 v[130:131], v[128:129], v[52:53], v[130:131] op_sel:[1,1,0] op_sel_hi:[1,0,1] neg_lo:[1,0,0]
    v_pk_fma_f32 v[134:135], v[132:133], v[52:53], v[134:135] op_sel:[1,1,0] op_sel_hi:[1,0,1] neg_lo:[1,0,0]
    v_pk_fma_f32 v[138:139], v[136:137], v[52:53], v[138:139] op_sel:[1,1,0] op_sel_hi:[1,0,1] neg_lo:[1,0,0]
    v_pk_fma_f32 v[142:143], v[140:141], v[52:53], v[142:143] op_sel:[1,1,0] op_sel_hi:[1,0,1] neg_lo:[1,0,0]
    v_pk_fma_f32 v[146:147], v[144:145], v[52:53], v[146:147] op_sel:[1,1,0] op_sel_hi:[1,0,1] neg_lo:[1,0,0]
    v_pk_fma_f32 v[150:151], v[148:149], v[52:53], v[150:151] op_sel:[1,1,0] op_sel_hi:[1,0,1] neg_lo:[1,0,0]
    v_pk_fma_f32 v[154:155], v[152:153], v[52:53], v[154:155] op_sel:[1,1,0] op_sel_hi:[1,0,1] neg_lo:[1,0,0]
    v_pk_fma_f32 v[158:159], v[156:157], v[52:53], v[158:159] op_sel:[1,1,0] op_sel_hi:[1,0,1] neg_lo:[1,0,0]
    v_pk_fma_f32 v[138:139], v[142:143], v[48:49], v[138:139] op_sel:[0,0,0] op_sel_hi:[0,1,1]
    v_pk_fma_f32 v[154:155], v[158:159], v[48:49], v[154:155] op_sel:[0,0,0] op_sel_hi:[0,1,1]
    v_pk_fma_f32 v[138:139], v[142:143], v[48:49], v[138:139] op_sel:[1,1,0] op_sel_hi:[1,0,1] neg_lo:[1,0,0]
    v_pk_fma_f32 v[154:155], v[158:159], v[48:49], v[154:155] op_sel:[1,1,0] op_sel_hi:[1,0,1] neg_lo:[1,0,0]
    v_pk_fma_f32 v[134:135], v[138:139], v[48:49], v[134:135] op_sel:[0,0,0] op_sel_hi:[0,1,1]
    v_pk_fma_f32 v[150:151], v[154:155], v[48:49], v[150:151] op_sel:[0,0,0] op_sel_hi:[0,1,1]
    v_pk_fma_f32 v[134:135], v[138:139], v[48:49], v[134:135] op_sel:[1,1,0] op_sel_hi:[1,0,1] neg_lo:[1,0,0]
    v_pk_fma_f32 v[150:151], v[154:155], v[48:49], v[150:151] op_sel:[1,1,0] op_sel_hi:[1,0,1] neg_lo:[1,0,0]
    v_pk_fma_f32 v[130:131], v[134:135], v[48:49], v[130:131] op_sel:[0,0,0] op_sel_hi:[0,1,1]
    v_pk_fma_f32 v[146:147], v[150:151], v[48:49], v[146:147] op_sel:[0,0,0] op_sel_hi:[0,1,1]
    v_pk_fma_f32 v[130:131], v[134:135], v[48:49], v[130:131] op_sel:[1,1,0] op_sel_hi:[1,0,1] neg_lo:[1,0,0]
    v_pk_fma_f32 v[146:147], v[150:151], v[48:49], v[146:147] op_sel:[1,1,0] op_sel_hi:[1,0,1] neg_lo:[1,0,0]
    v_pk_fma_f32 v[130:131], v[146:147], v[60:61], v[130:131] op_sel:[0,0,0] op_sel_hi:[0,1,1]
    v_pk_fma_f32 v[130:131], v[146:147], v[60:61], v[130:131] op_sel:[1,1,0] op_sel_hi:[1,0,1] neg_lo:[1,0,0]
    v_mov_b32 v60, v130
    v_mov_b32 v61, v131
    s_nop 0
    v_permlane32_swap_b32 v60, v130
    v_permlane32_swap_b32 v61, v131
    v_pk_fma_f32 v[60:61], v[130:131], v[54:55], v[60:61] op_sel:[0,0,0] op_sel_hi:[0,1,1]
    v_pk_fma_f32 v[60:61], v[130:131], v[54:55], v[60:61] op_sel:[1,1,0] op_sel_hi:[1,0,1] neg_lo:[1,0,0]
    s_waitcnt lgkmcnt(0)
    s_cmp_eq_u32 s68, 0
    s_cbranch_scc1 L_A_i0
    v_pk_fma_f32 v[28:29], v[60:61], v[52:53], v[28:29] op_sel:[0,0,0] op_sel_hi:[0,1,1]
    v_pk_fma_f32 v[28:29], v[60:61], v[52:53], v[28:29] op_sel:[1,1,0] op_sel_hi:[1,0,1] neg_lo:[1,0,0]
    v_mov_b32 v60, v28
    v_mov_b32 v61, v29
L_A_i0:
    v_pk_fma_f32 v[56:57], v[60:61], v[50:51], v[56:57] op_sel:[0,0,0] op_sel_hi:[0,1,1]
    v_pk_fma_f32 v[56:57], v[60:61], v[50:51], v[56:57] op_sel:[1,1,0] op_sel_hi:[1,0,1] neg_lo:[1,0,0]
    v_cmp_eq_u32 vcc, 1, v4
    s_nop 1
    v_cndmask_b32 v60, v60, v56, vcc
    v_cndmask_b32 v61, v61, v57, vcc
    v_pk_fma_f32 v[62:63], v[192:193], v[60:61], v[62:63] op_sel:[0,0,0] op_sel_hi:[1,0,1]
    v_pk_fma_f32 v[64:65], v[194:195], v[60:61], v[64:65] op_sel:[0,0,0] op_sel_hi:[1,0,1]
    v_pk_fma_f32 v[66:67], v[196:197], v[60:61], v[66:67] op_sel:[0,0,0] op_sel_hi:[1,0,1]
    v_pk_fma_f32 v[68:69], v[198:199], v[60:61], v[68:69] op_sel:[0,0,0] op_sel_hi:[1,0,1]
    v_pk_fma_f32 v[70:71], v[200:201], v[60:61], v[70:71] op_sel:[0,0,0] op_sel_hi:[1,0,1]
    v_pk_fma_f32 v[72:73], v[202:203], v[60:61], v[72:73] op_sel:[0,0,0] op_sel_hi:[1,0,1]
    v_pk_fma_f32 v[74:75], v[204:205], v[60:61], v[74:75] op_sel:[0,0,0] op_sel_hi:[1,0,1]
    v_pk_fma_f32 v[76:77], v[206:207], v[60:61], v[76:77] op_sel:[0,0,0] op_sel_hi:[1,0,1]
    v_pk_fma_f32 v[78:79], v[208:209], v[60:61], v[78:79] op_sel:[0,0,0] op_sel_hi:[1,0,1]
    v_pk_fma_f32 v[80:81], v[210:211], v[60:61], v[80:81] op_sel:[0,0,0] op_sel_hi:[1,0,1]
    v_pk_fma_f32 v[82:83], v[212:213], v[60:61], v[82:83] op_sel:[0,0,0] op_sel_hi:[1,0,1]
    v_pk_fma_f32 v[84:85], v[214:215], v[60:61], v[84:85] op_sel:[0,0,0] op_sel_hi:[1,0,1]
    v_pk_fma_f32 v[86:87], v[216:217], v[60:61], v[86:87] op_sel:[0,0,0] op_sel_hi:[1,0,1]
    v_pk_fma_f32 v[88:89], v[218:219], v[60:61], v[88:89] op_sel:[0,0,0] op_sel_hi:[1,0,1]
    v_pk_fma_f32 v[90:91], v[220:221], v[60:61], v[90:91] op_sel:[0,0,0] op_sel_hi:[1,0,1]
    v_pk_fma_f32 v[92:93], v[222:223], v[60:61], v[92:93] op_sel:[0,0,0] op_sel_hi:[1,0,1]
    v_pk_fma_f32 v[62:63], v[224:225], v[60:61], v[62:63] op_sel:[0,1,0] op_sel_hi:[1,1,1] neg_lo:[1,0,0] neg_hi:[1,0,0]
    v_pk_fma_f32 v[64:65], v[226:227], v[60:61], v[64:65] op_sel:[0,1,0] op_sel_hi:[1,1,1] neg_lo:[1,0,0] neg_hi:[1,0,0]
    v_pk_fma_f32 v[66:67], v[228:229], v[60:61], v[66:67] op_sel:[0,1,0] op_sel_hi:[1,1,1] neg_lo:[1,0,0] neg_hi:[1,0,0]
    v_pk_fma_f32 v[68:69], v[230:231], v[60:61], v[68:69] op_sel:[0,1,0] op_sel_hi:[1,1,1] neg_lo:[1,0,0] neg_hi:[1,0,0]
    v_pk_fma_f32 v[70:71], v[232:233], v[60:61], v[70:71] op_sel:[0,1,0] op_sel_hi:[1,1,1] neg_lo:[1,0,0] neg_hi:[1,0,0]
    v_pk_fma_f32 v[72:73], v[234:235], v[60:61], v[72:73] op_sel:[0,1,0] op_sel_hi:[1,1,1] neg_lo:[1,0,0] neg_hi:[1,0,0]
    v_pk_fma_f32 v[74:75], v[236:237], v[60:61], v[74:75] op_sel:[0,1,0] op_sel_hi:[1,1,1] neg_lo:[1,0,0] neg_hi:[1,0,0]
    v_pk_fma_f32 v[76:77], v[238:239], v[60:61], v[76:77] op_sel:[0,1,0] op_sel_hi:[1,1,1] neg_lo:[1,0,0] neg_hi:[1,0,0]
    v_pk_fma_f32 v[78:79], v[240:241], v[60:61], v[78:79] op_sel:[0,1,0] op_sel_hi:[1,1,1] neg_lo:[1,0,0] neg_hi:[1,0,0]
    v_pk_fma_f32 v[80:81], v[242:243], v[60:61], v[80:81] op_sel:[0,1,0] op_sel_hi:[1,1,1] neg_lo:[1,0,0] neg_hi:[1,0,0]
    v_pk_fma_f32 v[82:83], v[244:245], v[60:61], v[82:83] op_sel:[0,1,0] op_sel_hi:[1,1,1] neg_lo:[1,0,0] neg_hi:[1,0,0]
    v_pk_fma_f32 v[84:85], v[246:247], v[60:61], v[84:85] op_sel:[0,1,0] op_sel_hi:[1,1,1] neg_lo:[1,0,0] neg_hi:[1,0,0]
    v_pk_fma_f32 v[86:87], v[248:249], v[60:61], v[86:87] op_sel:[0,1,0] op_sel_hi:[1,1,1] neg_lo:[1,0,0] neg_hi:[1,0,0]
    v_pk_fma_f32 v[88:89], v[250:251], v[60:61], v[88:89] op_sel:[0,1,0] op_sel_hi:[1,1,1] neg_lo:[1,0,0] neg_hi:[1,0,0]
    v_pk_fma_f32 v[90:91], v[252:253], v[60:61], v[90:91] op_sel:[0,1,0] op_sel_hi:[1,1,1] neg_lo:[1,0,0] neg_hi:[1,0,0]
    v_pk_fma_f32 v[92:93], v[254:255], v[60:61], v[92:93] op_sel:[0,1,0] op_sel_hi:[1,1,1] neg_lo:[1,0,0] neg_hi:[1,0,0]
    v_cvt_pk_bf16_f32 v62, v62, v63
    v_cvt_pk_bf16_f32 v63, v64, v65
    v_cvt_pk_bf16_f32 v64, v66, v67
    v_cvt_pk_bf16_f32 v65, v68, v69
    ds_write_b128 v32, v[62:65]
    v_cvt_pk_bf16_f32 v66, v70, v71
    v_cvt_pk_bf16_f32 v67, v72, v73
    v_cvt_pk_bf16_f32 v68, v74, v75
    v_cvt_pk_bf16_f32 v69, v76, v77
    ds_write_b128 v33, v[66:69]
    v_cvt_pk_bf16_f32 v70, v78, v79
    v_cvt_pk_bf16_f32 v71, v80, v81
    v_cvt_pk_bf16_f32 v72, v82, v83
    v_cvt_pk_bf16_f32 v73, v84, v85
    ds_write_b128 v34, v[70:73]
    v_cvt_pk_bf16_f32 v74, v86, v87
    v_cvt_pk_bf16_f32 v75, v88, v89
    v_cvt_pk_bf16_f32 v76, v90, v91
    v_cvt_pk_bf16_f32 v77, v92, v93
    ds_write_b128 v35, v[74:77]
    ds_read_b64_tr_b16 v[78:79], v45 offset:0
    ds_read_b64_tr_b16 v[80:81], v45 offset:576
    ds_read_b64_tr_b16 v[82:83], v45 offset:2048
    ds_read_b64_tr_b16 v[84:85], v45 offset:2624
    ds_read_b64_tr_b16 v[86:87], v45 offset:64
    ds_read_b64_tr_b16 v[88:89], v45 offset:512
    ds_read_b64_tr_b16 v[90:91], v45 offset:2112
    ds_read_b64_tr_b16 v[92:93], v45 offset:2560
    v_pk_fma_f32 v[96:97], v[192:193], v[60:61], v[96:97] op_sel:[0,1,0] op_sel_hi:[1,1,1] neg_lo:[1,0,0] neg_hi:[1,0,0]
    v_pk_fma_f32 v[98:99], v[194:195], v[60:61], v[98:99] op_sel:[0,1,0] op_sel_hi:[1,1,1] neg_lo:[1,0,0] neg_hi:[1,0,0]
    v_pk_fma_f32 v[100:101], v[196:197], v[60:61], v[100:101] op_sel:[0,1,0] op_sel_hi:[1,1,1] neg_lo:[1,0,0] neg_hi:[1,0,0]
    v_pk_fma_f32 v[102:103], v[198:199], v[60:61], v[102:103] op_sel:[0,1,0] op_sel_hi:[1,1,1] neg_lo:[1,0,0] neg_hi:[1,0,0]
    v_pk_fma_f32 v[104:105], v[200:201], v[60:61], v[104:105] op_sel:[0,1,0] op_sel_hi:[1,1,1] neg_lo:[1,0,0] neg_hi:[1,0,0]
    v_pk_fma_f32 v[106:107], v[202:203], v[60:61], v[106:107] op_sel:[0,1,0] op_sel_hi:[1,1,1] neg_lo:[1,0,0] neg_hi:[1,0,0]
    v_pk_fma_f32 v[108:109], v[204:205], v[60:61], v[108:109] op_sel:[0,1,0] op_sel_hi:[1,1,1] neg_lo:[1,0,0] neg_hi:[1,0,0]
    v_pk_fma_f32 v[110:111], v[206:207], v[60:61], v[110:111] op_sel:[0,1,0] op_sel_hi:[1,1,1] neg_lo:[1,0,0] neg_hi:[1,0,0]
    v_pk_fma_f32 v[112:113], v[208:209], v[60:61], v[112:113] op_sel:[0,1,0] op_sel_hi:[1,1,1] neg_lo:[1,0,0] neg_hi:[1,0,0]
    v_pk_fma_f32 v[114:115], v[210:211], v[60:61], v[114:115] op_sel:[0,1,0] op_sel_hi:[1,1,1] neg_lo:[1,0,0] neg_hi:[1,0,0]
    v_pk_fma_f32 v[116:117], v[212:213], v[60:61], v[116:117] op_sel:[0,1,0] op_sel_hi:[1,1,1] neg_lo:[1,0,0] neg_hi:[1,0,0]
    v_pk_fma_f32 v[118:119], v[214:215], v[60:61], v[118:119] op_sel:[0,1,0] op_sel_hi:[1,1,1] neg_lo:[1,0,0] neg_hi:[1,0,0]
    v_pk_fma_f32 v[120:121], v[216:217], v[60:61], v[120:121] op_sel:[0,1,0] op_sel_hi:[1,1,1] neg_lo:[1,0,0] neg_hi:[1,0,0]
    v_pk_fma_f32 v[122:123], v[218:219], v[60:61], v[122:123] op_sel:[0,1,0] op_sel_hi:[1,1,1] neg_lo:[1,0,0] neg_hi:[1,0,0]
    v_pk_fma_f32 v[124:125], v[220:221], v[60:61], v[124:125] op_sel:[0,1,0] op_sel_hi:[1,1,1] neg_lo:[1,0,0] neg_hi:[1,0,0]
    v_pk_fma_f32 v[126:127], v[222:223], v[60:61], v[126:127] op_sel:[0,1,0] op_sel_hi:[1,1,1] neg_lo:[1,0,0] neg_hi:[1,0,0]
    s_waitcnt lgkmcnt(4)
    buffer_store_dwordx4 v[78:81], v38, s[76:79], 0 offen offset:0 sc1
    buffer_store_dwordx4 v[82:85], v38, s[76:79], 0 offen offset:1024 sc1
    s_waitcnt lgkmcnt(0)
    buffer_store_dwordx4 v[86:89], v38, s[76:79], s70 offen offset:0 sc1
    buffer_store_dwordx4 v[90:93], v38, s[76:79], s70 offen offset:1024 sc1
    v_pk_fma_f32 v[96:97], v[224:225], v[60:61], v[96:97] op_sel:[0,0,0] op_sel_hi:[1,0,1] neg_lo:[1,0,0] neg_hi:[1,0,0]
    v_pk_fma_f32 v[98:99], v[226:227], v[60:61], v[98:99] op_sel:[0,0,0] op_sel_hi:[1,0,1] neg_lo:[1,0,0] neg_hi:[1,0,0]
    v_pk_fma_f32 v[100:101], v[228:229], v[60:61], v[100:101] op_sel:[0,0,0] op_sel_hi:[1,0,1] neg_lo:[1,0,0] neg_hi:[1,0,0]
    v_pk_fma_f32 v[102:103], v[230:231], v[60:61], v[102:103] op_sel:[0,0,0] op_sel_hi:[1,0,1] neg_lo:[1,0,0] neg_hi:[1,0,0]
    v_pk_fma_f32 v[104:105], v[232:233], v[60:61], v[104:105] op_sel:[0,0,0] op_sel_hi:[1,0,1] neg_lo:[1,0,0] neg_hi:[1,0,0]
    v_pk_fma_f32 v[106:107], v[234:235], v[60:61], v[106:107] op_sel:[0,0,0] op_sel_hi:[1,0,1] neg_lo:[1,0,0] neg_hi:[1,0,0]
    v_pk_fma_f32 v[108:109], v[236:237], v[60:61], v[108:109] op_sel:[0,0,0] op_sel_hi:[1,0,1] neg_lo:[1,0,0] neg_hi:[1,0,0]
    v_pk_fma_f32 v[110:111], v[238:239], v[60:61], v[110:111] op_sel:[0,0,0] op_sel_hi:[1,0,1] neg_lo:[1,0,0] neg_hi:[1,0,0]
    v_pk_fma_f32 v[112:113], v[240:241], v[60:61], v[112:113] op_sel:[0,0,0] op_sel_hi:[1,0,1] neg_lo:[1,0,0] neg_hi:[1,0,0]
    v_pk_fma_f32 v[114:115], v[242:243], v[60:61], v[114:115] op_sel:[0,0,0] op_sel_hi:[1,0,1] neg_lo:[1,0,0] neg_hi:[1,0,0]
    v_pk_fma_f32 v[116:117], v[244:245], v[60:61], v[116:117] op_sel:[0,0,0] op_sel_hi:[1,0,1] neg_lo:[1,0,0] neg_hi:[1,0,0]
    v_pk_fma_f32 v[118:119], v[246:247], v[60:61], v[118:119] op_sel:[0,0,0] op_sel_hi:[1,0,1] neg_lo:[1,0,0] neg_hi:[1,0,0]
    v_pk_fma_f32 v[120:121], v[248:249], v[60:61], v[120:121] op_sel:[0,0,0] op_sel_hi:[1,0,1] neg_lo:[1,0,0] neg_hi:[1,0,0]
    v_pk_fma_f32 v[122:123], v[250:251], v[60:61], v[122:123] op_sel:[0,0,0] op_sel_hi:[1,0,1] neg_lo:[1,0,0] neg_hi:[1,0,0]
    v_pk_fma_f32 v[124:125], v[252:253], v[60:61], v[124:125] op_sel:[0,0,0] op_sel_hi:[1,0,1] neg_lo:[1,0,0] neg_hi:[1,0,0]
    v_pk_fma_f32 v[126:127], v[254:255], v[60:61], v[126:127] op_sel:[0,0,0] op_sel_hi:[1,0,1] neg_lo:[1,0,0] neg_hi:[1,0,0]
    v_cvt_pk_bf16_f32 v96, v96, v97
    v_cvt_pk_bf16_f32 v97, v98, v99
    v_cvt_pk_bf16_f32 v98, v100, v101
    v_cvt_pk_bf16_f32 v99, v102, v103
    ds_write_b128 v32, v[96:99]
    v_cvt_pk_bf16_f32 v100, v104, v105
    v_cvt_pk_bf16_f32 v101, v106, v107
    v_cvt_pk_bf16_f32 v102, v108, v109
    v_cvt_pk_bf16_f32 v103, v110, v111
    ds_write_b128 v33, v[100:103]
    v_cvt_pk_bf16_f32 v104, v112, v113
    v_cvt_pk_bf16_f32 v105, v114, v115
    v_cvt_pk_bf16_f32 v106, v116, v117
    v_cvt_pk_bf16_f32 v107, v118, v119
    ds_write_b128 v34, v[104:107]
    v_cvt_pk_bf16_f32 v108, v120, v121
    v_cvt_pk_bf16_f32 v109, v122, v123
    v_cvt_pk_bf16_f32 v110, v124, v125
    v_cvt_pk_bf16_f32 v111, v126, v127
    ds_write_b128 v35, v[108:111]
    ds_read_b64_tr_b16 v[112:113], v45 offset:0
    ds_read_b64_tr_b16 v[114:115], v45 offset:576
    ds_read_b64_tr_b16 v[116:117], v45 offset:2048
    ds_read_b64_tr_b16 v[118:119], v45 offset:2624
    ds_read_b64_tr_b16 v[120:121], v45 offset:64
    ds_read_b64_tr_b16 v[122:123], v45 offset:512
    ds_read_b64_tr_b16 v[124:125], v45 offset:2112
    ds_read_b64_tr_b16 v[126:127], v45 offset:2560
    s_waitcnt lgkmcnt(4)
    buffer_store_dwordx4 v[112:115], v38, s[76:79], s69 offen offset:0 sc1
    buffer_store_dwordx4 v[116:119], v38, s[76:79], s69 offen offset:1024 sc1
    s_waitcnt lgkmcnt(0)
    buffer_store_dwordx4 v[120:123], v38, s[76:79], s71 offen offset:0 sc1
    buffer_store_dwordx4 v[124:127], v38, s[76:79], s71 offen offset:1024 sc1
    v_and_b32 v28, 1, v3
    v_lshlrev_b32 v28, 4, v28
    v_mov_b32 v29, 0x3f80
    v_lshlrev_b32 v29, v28, v29
    v_bfe_u32 v28, v3, 3, 1
    v_cmp_eq_u32 vcc, v28, v4
    s_nop 1
    v_cndmask_b32 v29, 0, v29, vcc
    v_lshrrev_b32 v28, 4, v3
    v_bfe_u32 v30, v3, 1, 2
    v_lshl_add_u32 v28, v28, 2, v30
    v_cmp_eq_u32 vcc, 0, v28
    s_nop 1
    v_cndmask_b32 v96, 0, v29, vcc
    v_cmp_eq_u32 vcc, 1, v28
    s_nop 1
    v_cndmask_b32 v97, 0, v29, vcc
    v_cmp_eq_u32 vcc, 2, v28
    s_nop 1
    v_cndmask_b32 v98, 0, v29, vcc
    v_cmp_eq_u32 vcc, 3, v28
    s_nop 1
    v_cndmask_b32 v99, 0, v29, vcc
    v_cmp_eq_u32 vcc, 4, v28
    s_nop 1
    v_cndmask_b32 v100, 0, v29, vcc
    v_cmp_eq_u32 vcc, 5, v28
    s_nop 1
    v_cndmask_b32 v101, 0, v29, vcc
    v_cmp_eq_u32 vcc, 6, v28
    s_nop 1
    v_cndmask_b32 v102, 0, v29, vcc
    v_cmp_eq_u32 vcc, 7, v28
    s_nop 1
    v_cndmask_b32 v103, 0, v29, vcc
    v_mov_b32 v31, 0xffff0000
    s_waitcnt vmcnt(8)
    v_lshlrev_b32 v104, 16, v160
    v_lshlrev_b32 v105, 16, v176
    v_and_b32 v160, v31, v160
    v_and_b32 v176, v31, v176
    v_mul_f32 v104, v104, v105
    v_mul_f32 v160, v160, v176
    v_cvt_pk_bf16_f32 v160, v104, v160
    v_lshlrev_b32 v106, 16, v161
    v_lshlrev_b32 v107, 16, v177
    v_and_b32 v161, v31, v161
    v_and_b32 v177, v31, v177
    v_mul_f32 v106, v106, v107
    v_mul_f32 v161, v161, v177
    v_cvt_pk_bf16_f32 v161, v106, v161
    v_lshlrev_b32 v108, 16, v162
    v_lshlrev_b32 v109, 16, v178
    v_and_b32 v162, v31, v162
    v_and_b32 v178, v31, v178
    v_mul_f32 v108, v108, v109
    v_mul_f32 v162, v162, v178
    v_cvt_pk_bf16_f32 v162, v108, v162
    v_lshlrev_b32 v110, 16, v163
    v_lshlrev_b32 v111, 16, v179
    v_and_b32 v163, v31, v163
    v_and_b32 v179, v31, v179
    v_mul_f32 v110, v110, v111
    v_mul_f32 v163, v163, v179
    v_cvt_pk_bf16_f32 v163, v110, v163
    s_nop 1
    v_mfma_f32_32x32x16_bf16 v[128:143], v[160:163], v[96:99], 0
    v_lshlrev_b32 v104, 16, v164
    v_lshlrev_b32 v105, 16, v180
    v_and_b32 v164, v31, v164
    v_and_b32 v180, v31, v180
    v_mul_f32 v104, v104, v105
    v_mul_f32 v164, v164, v180
    v_cvt_pk_bf16_f32 v164, v104, v164
    v_lshlrev_b32 v106, 16, v165
    v_lshlrev_b32 v107, 16, v181
    v_and_b32 v165, v31, v165
    v_and_b32 v181, v31, v181
    v_mul_f32 v106, v106, v107
    v_mul_f32 v165, v165, v181
    v_cvt_pk_bf16_f32 v165, v106, v165
    v_lshlrev_b32 v108, 16, v166
    v_lshlrev_b32 v109, 16, v182
    v_and_b32 v166, v31, v166
    v_and_b32 v182, v31, v182
    v_mul_f32 v108, v108, v109
    v_mul_f32 v166, v166, v182
    v_cvt_pk_bf16_f32 v166, v108, v166
    v_lshlrev_b32 v110, 16, v167
    v_lshlrev_b32 v111, 16, v183
    v_and_b32 v167, v31, v167
    v_and_b32 v183, v31, v183
    v_mul_f32 v110, v110, v111
    v_mul_f32 v167, v167, v183
    v_cvt_pk_bf16_f32 v167, v110, v167
    s_nop 1
    v_mfma_f32_32x32x16_bf16 v[128:143], v[164:167], v[100:103], v[128:143]
    v_lshlrev_b32 v104, 16, v168
    v_lshlrev_b32 v105, 16, v184
    v_and_b32 v168, v31, v168
    v_and_b32 v184, v31, v184
    v_mul_f32 v104, v104, v105
    v_mul_f32 v168, v168, v184
    v_cvt_pk_bf16_f32 v168, v104, v168
    v_lshlrev_b32 v106, 16, v169
    v_lshlrev_b32 v107, 16, v185
    v_and_b32 v169, v31, v169
    v_and_b32 v185, v31, v185
    v_mul_f32 v106, v106, v107
    v_mul_f32 v169, v169, v185
    v_cvt_pk_bf16_f32 v169, v106, v169
    v_lshlrev_b32 v108, 16, v170
    v_lshlrev_b32 v109, 16, v186
    v_and_b32 v170, v31, v170
    v_and_b32 v186, v31, v186
    v_mul_f32 v108, v108, v109
    v_mul_f32 v170, v170, v186
    v_cvt_pk_bf16_f32 v170, v108, v170
    v_lshlrev_b32 v110, 16, v171
    v_lshlrev_b32 v111, 16, v187
    v_and_b32 v171, v31, v171
    v_and_b32 v187, v31, v187
    v_mul_f32 v110, v110, v111
    v_mul_f32 v171, v171, v187
    v_cvt_pk_bf16_f32 v171, v110, v171
    s_nop 1
    v_mfma_f32_32x32x16_bf16 v[144:159], v[168:171], v[96:99], 0
    v_lshlrev_b32 v104, 16, v172
    v_lshlrev_b32 v105, 16, v188
    v_and_b32 v172, v31, v172
    v_and_b32 v188, v31, v188
    v_mul_f32 v104, v104, v105
    v_mul_f32 v172, v172, v188
    v_cvt_pk_bf16_f32 v172, v104, v172
    v_lshlrev_b32 v106, 16, v173
    v_lshlrev_b32 v107, 16, v189
    v_and_b32 v173, v31, v173
    v_and_b32 v189, v31, v189
    v_mul_f32 v106, v106, v107
    v_mul_f32 v173, v173, v189
    v_cvt_pk_bf16_f32 v173, v106, v173
    v_lshlrev_b32 v108, 16, v174
    v_lshlrev_b32 v109, 16, v190
    v_and_b32 v174, v31, v174
    v_and_b32 v190, v31, v190
    v_mul_f32 v108, v108, v109
    v_mul_f32 v174, v174, v190
    v_cvt_pk_bf16_f32 v174, v108, v174
    v_lshlrev_b32 v110, 16, v175
    v_lshlrev_b32 v111, 16, v191
    v_and_b32 v175, v31, v175
    v_and_b32 v191, v31, v191
    v_mul_f32 v110, v110, v111
    v_mul_f32 v175, v175, v191
    v_cvt_pk_bf16_f32 v175, v110, v175
    s_nop 1
    v_mfma_f32_32x32x16_bf16 v[144:159], v[172:175], v[100:103], v[144:159]
    v_mov_b32 v28, s15
    v_mov_b32 v29, 1
    s_waitcnt vmcnt(0)
    s_barrier
    ds_read_b128 v[64:67], v16 offset:0
    ds_read_b128 v[68:71], v16 offset:4096
    ds_read_b128 v[72:75], v17 offset:0
    ds_read_b128 v[76:79], v17 offset:4096
    ds_read_b128 v[80:83], v18 offset:0
    ds_read_b128 v[84:87], v18 offset:4096
    s_mov_b32 s15, 0x40000000
    s_mov_b32 s16, 0x40000000
    buffer_load_dwordx4 v[192:195], v39, s[76:79], s6 offen offset:0 sc1
    buffer_load_dwordx4 v[196:199], v39, s[76:79], s6 offen offset:1024 sc1
    buffer_load_dwordx4 v[200:203], v39, s[76:79], s6 offen offset:2048 sc1
    buffer_load_dwordx4 v[204:207], v39, s[76:79], s6 offen offset:3072 sc1
    buffer_load_dwordx4 v[208:211], v40, s[76:79], s6 offen offset:0 sc1
    buffer_load_dwordx4 v[212:215], v40, s[76:79], s6 offen offset:1024 sc1
    buffer_load_dwordx4 v[216:219], v40, s[76:79], s6 offen offset:2048 sc1
    buffer_load_dwordx4 v[220:223], v40, s[76:79], s6 offen offset:3072 sc1
    s_barrier
    buffer_load_dwordx4 v[224:227], v39, s[76:79], s7 offen offset:0 sc1
    buffer_load_dwordx4 v[228:231], v39, s[76:79], s7 offen offset:1024 sc1
    buffer_load_dwordx4 v[232:235], v39, s[76:79], s7 offen offset:2048 sc1
    buffer_load_dwordx4 v[236:239], v39, s[76:79], s7 offen offset:3072 sc1
    buffer_load_dwordx4 v[240:243], v40, s[76:79], s7 offen offset:0 sc1
    buffer_load_dwordx4 v[244:247], v40, s[76:79], s7 offen offset:1024 sc1
    buffer_load_dwordx4 v[248:251], v40, s[76:79], s7 offen offset:2048 sc1
    buffer_load_dwordx4 v[252:255], v40, s[76:79], s7 offen offset:3072 sc1
    s_mov_b32 s66, 0
L_A_g2:
    s_waitcnt vmcnt(15) lgkmcnt(4)
    v_mfma_f32_32x32x16_bf16 v[128:143], v[192:195], v[64:67], v[128:143]
    ds_read_b128 v[88:91], v19 offset:0
    ds_read_b128 v[92:95], v19 offset:4096
    v_mfma_f32_32x32x16_bf16 v[144:159], v[192:195], v[68:71], v[144:159]
    buffer_load_dwordx4 v[160:163], v39, s[76:79], s8 offen offset:0 sc1
    s_waitcnt vmcnt(15) lgkmcnt(4)
    v_mfma_f32_32x32x16_bf16 v[128:143], v[196:199], v[72:75], v[128:143]
    ds_read_b128 v[64:67], v16 offset:8192
    ds_read_b128 v[68:71], v16 offset:12288
    v_mfma_f32_32x32x16_bf16 v[144:159], v[196:199], v[76:79], v[144:159]
    buffer_load_dwordx4 v[164:167], v39, s[76:79], s8 offen offset:1024 sc1
    s_waitcnt vmcnt(15) lgkmcnt(4)
    v_mfma_f32_32x32x16_bf16 v[128:143], v[200:203], v[80:83], v[128:143]
    ds_read_b128 v[72:75], v17 offset:8192
    ds_read_b128 v[76:79], v17 offset:12288
    v_mfma_f32_32x32x16_bf16 v[144:159], v[200:203], v[84:87], v[144:159]
    buffer_load_dwordx4 v[168:171], v39, s[76:79], s8 offen offset:2048 sc1
    s_waitcnt vmcnt(15) lgkmcnt(4)
    v_mfma_f32_32x32x16_bf16 v[128:143], v[204:207], v[88:91], v[128:143]
    ds_read_b128 v[80:83], v18 offset:8192
    ds_read_b128 v[84:87], v18 offset:12288
    v_mfma_f32_32x32x16_bf16 v[144:159], v[204:207], v[92:95], v[144:159]
    buffer_load_dwordx4 v[172:175], v39, s[76:79], s8 offen offset:3072 sc1
    s_waitcnt vmcnt(15) lgkmcnt(4)
    v_mfma_f32_32x32x16_bf16 v[128:143], v[208:211], v[64:67], v[128:143]
    ds_read_b128 v[88:91], v19 offset:8192
    ds_read_b128 v[92:95], v19 offset:12288
    v_mfma_f32_32x32x16_bf16 v[144:159], v[208:211], v[68:71], v[144:159]
    buffer_load_dwordx4 v[176:179], v40, s[76:79], s8 offen offset:0 sc1
    s_waitcnt vmcnt(15) lgkmcnt(4)
    v_mfma_f32_32x32x16_bf16 v[128:143], v[212:215], v[72:75], v[128:143]
    ds_read_b128 v[64:67], v16 offset:16384
    ds_read_b128 v[68:71], v16 offset:20480
    v_mfma_f32_32x32x16_bf16 v[144:159], v[212:215], v[76:79], v[144:159]
    buffer_load_dwordx4 v[180:183], v40, s[76:79], s8 offen offset:1024 sc1
    s_waitcnt vmcnt(15) lgkmcnt(4)
    v_mfma_f32_32x32x16_bf16 v[128:143], v[216:219], v[80:83], v[128:143]
    ds_read_b128 v[72:75], v17 offset:16384
    ds_read_b128 v[76:79], v17 offset:20480
    v_mfma_f32_32x32x16_bf16 v[144:159], v[216:219], v[84:87], v[144:159]
    buffer_load_dwordx4 v[184:187], v40, s[76:79], s8 offen offset:2048 sc1
    s_waitcnt vmcnt(15) lgkmcnt(4)
    v_mfma_f32_32x32x16_bf16 v[128:143], v[220:223], v[88:91], v[128:143]
    ds_read_b128 v[80:83], v18 offset:16384
    ds_read_b128 v[84:87], v18 offset:20480
    v_mfma_f32_32x32x16_bf16 v[144:159], v[220:223], v[92:95], v[144:159]
    buffer_load_dwordx4 v[188:191], v40, s[76:79], s8 offen offset:3072 sc1
    s_mov_b32 s8, s11
    s_mov_b32 s11, s14
    s_waitcnt vmcnt(15) lgkmcnt(4)
    v_mfma_f32_32x32x16_bf16 v[128:143], v[224:227], v[64:67], v[128:143]
    ds_read_b128 v[88:91], v19 offset:16384
    ds_read_b128 v[92:95], v19 offset:20480
    v_mfma_f32_32x32x16_bf16 v[144:159], v[224:227], v[68:71], v[144:159]
    buffer_load_dwordx4 v[192:195], v39, s[76:79], s9 offen offset:0 sc1
    s_waitcnt vmcnt(15) lgkmcnt(4)
    v_mfma_f32_32x32x16_bf16 v[128:143], v[228:231], v[72:75], v[128:143]
    ds_read_b128 v[64:67], v16 offset:24576
    ds_read_b128 v[68:71], v16 offset:28672
    v_mfma_f32_32x32x16_bf16 v[144:159], v[228:231], v[76:79], v[144:159]
    buffer_load_dwordx4 v[196:199], v39, s[76:79], s9 offen offset:1024 sc1
    s_waitcnt vmcnt(15) lgkmcnt(4)
    v_mfma_f32_32x32x16_bf16 v[128:143], v[232:235], v[80:83], v[128:143]
    ds_read_b128 v[72:75], v17 offset:24576
    ds_read_b128 v[76:79], v17 offset:28672
    v_mfma_f32_32x32x16_bf16 v[144:159], v[232:235], v[84:87], v[144:159]
    buffer_load_dwordx4 v[200:203], v39, s[76:79], s9 offen offset:2048 sc1
    s_waitcnt vmcnt(15) lgkmcnt(4)
    v_mfma_f32_32x32x16_bf16 v[128:143], v[236:239], v[88:91], v[128:143]
    ds_read_b128 v[80:83], v18 offset:24576
    ds_read_b128 v[84:87], v18 offset:28672
    v_mfma_f32_32x32x16_bf16 v[144:159], v[236:239], v[92:95], v[144:159]
    buffer_load_dwordx4 v[204:207], v39, s[76:79], s9 offen offset:3072 sc1
    s_waitcnt vmcnt(15) lgkmcnt(4)
    v_mfma_f32_32x32x16_bf16 v[128:143], v[240:243], v[64:67], v[128:143]
    ds_read_b128 v[88:91], v19 offset:24576
    ds_read_b128 v[92:95], v19 offset:28672
    v_mfma_f32_32x32x16_bf16 v[144:159], v[240:243], v[68:71], v[144:159]
    buffer_load_dwordx4 v[208:211], v40, s[76:79], s9 offen offset:0 sc1
    s_waitcnt vmcnt(15) lgkmcnt(4)
    v_mfma_f32_32x32x16_bf16 v[128:143], v[244:247], v[72:75], v[128:143]
    ds_read_b128 v[64:67], v16 offset:32768
    ds_read_b128 v[68:71], v16 offset:36864
    v_mfma_f32_32x32x16_bf16 v[144:159], v[244:247], v[76:79], v[144:159]
    buffer_load_dwordx4 v[212:215], v40, s[76:79], s9 offen offset:1024 sc1
    s_waitcnt vmcnt(15) lgkmcnt(4)
    v_mfma_f32_32x32x16_bf16 v[128:143], v[248:251], v[80:83], v[128:143]
    ds_read_b128 v[72:75], v17 offset:32768
    ds_read_b128 v[76:79], v17 offset:36864
    v_mfma_f32_32x32x16_bf16 v[144:159], v[248:251], v[84:87], v[144:159]
    buffer_load_dwordx4 v[216:219], v40, s[76:79], s9 offen offset:2048 sc1
    s_waitcnt vmcnt(15) lgkmcnt(4)
    v_mfma_f32_32x32x16_bf16 v[128:143], v[252:255], v[88:91], v[128:143]
    ds_read_b128 v[80:83], v18 offset:32768
    ds_read_b128 v[84:87], v18 offset:36864
    v_mfma_f32_32x32x16_bf16 v[144:159], v[252:255], v[92:95], v[144:159]
    buffer_load_dwordx4 v[220:223], v40, s[76:79], s9 offen offset:3072 sc1
    s_mov_b32 s9, s12
    s_mov_b32 s12, s15
    s_waitcnt vmcnt(15) lgkmcnt(4)
    v_mfma_f32_32x32x16_bf16 v[128:143], v[160:163], v[64:67], v[128:143]
    ds_read_b128 v[88:91], v19 offset:32768
    ds_read_b128 v[92:95], v19 offset:36864
    v_mfma_f32_32x32x16_bf16 v[144:159], v[160:163], v[68:71], v[144:159]
    buffer_load_dwordx4 v[224:227], v39, s[76:79], s10 offen offset:0 sc1
    s_waitcnt vmcnt(15) lgkmcnt(4)
    v_mfma_f32_32x32x16_bf16 v[128:143], v[164:167], v[72:75], v[128:143]
    ds_read_b128 v[64:67], v16 offset:40960
    ds_read_b128 v[68:71], v16 offset:45056
    v_mfma_f32_32x32x16_bf16 v[144:159], v[164:167], v[76:79], v[144:159]
    buffer_load_dwordx4 v[228:231], v39, s[76:79], s10 offen offset:1024 sc1
    s_waitcnt vmcnt(15) lgkmcnt(4)
    v_mfma_f32_32x32x16_bf16 v[128:143], v[168:171], v[80:83], v[128:143]
    ds_read_b128 v[72:75], v17 offset:40960
    ds_read_b128 v[76:79], v17 offset:45056
    v_mfma_f32_32x32x16_bf16 v[144:159], v[168:171], v[84:87], v[144:159]
    buffer_load_dwordx4 v[232:235], v39, s[76:79], s10 offen offset:2048 sc1
    s_waitcnt vmcnt(15) lgkmcnt(4)
    v_mfma_f32_32x32x16_bf16 v[128:143], v[172:175], v[88:91], v[128:143]
    ds_read_b128 v[80:83], v18 offset:40960
    ds_read_b128 v[84:87], v18 offset:45056
    v_mfma_f32_32x32x16_bf16 v[144:159], v[172:175], v[92:95], v[144:159]
    buffer_load_dwordx4 v[236:239], v39, s[76:79], s10 offen offset:3072 sc1
    s_waitcnt vmcnt(15) lgkmcnt(4)
    v_mfma_f32_32x32x16_bf16 v[128:143], v[176:179], v[64:67], v[128:143]
    ds_read_b128 v[88:91], v19 offset:40960
    ds_read_b128 v[92:95], v19 offset:45056
    v_add_u32 v19, 49152, v19
    v_mfma_f32_32x32x16_bf16 v[144:159], v[176:179], v[68:71], v[144:159]
    buffer_load_dwordx4 v[240:243], v40, s[76:79], s10 offen offset:0 sc1
    s_waitcnt vmcnt(15) lgkmcnt(4)
    v_mfma_f32_32x32x16_bf16 v[128:143], v[180:183], v[72:75], v[128:143]
    ds_read_b128 v[64:67], v16 offset:49152
    ds_read_b128 v[68:71], v16 offset:53248
    v_add_u32 v16, 49152, v16
    v_mfma_f32_32x32x16_bf16 v[144:159], v[180:183], v[76:79], v[144:159]
    buffer_load_dwordx4 v[244:247], v40, s[76:79], s10 offen offset:1024 sc1
    s_waitcnt vmcnt(15) lgkmcnt(4)
    v_mfma_f32_32x32x16_bf16 v[128:143], v[184:187], v[80:83], v[128:143]
    ds_read_b128 v[72:75], v17 offset:49152
    ds_read_b128 v[76:79], v17 offset:53248
    v_add_u32 v17, 49152, v17
    v_mfma_f32_32x32x16_bf16 v[144:159], v[184:187], v[84:87], v[144:159]
    buffer_load_dwordx4 v[248:251], v40, s[76:79], s10 offen offset:2048 sc1
    s_waitcnt vmcnt(15) lgkmcnt(4)
    v_mfma_f32_32x32x16_bf16 v[128:143], v[188:191], v[88:91], v[128:143]
    ds_read_b128 v[80:83], v18 offset:49152
    ds_read_b128 v[84:87], v18 offset:53248
    v_add_u32 v18, 49152, v18
    v_mfma_f32_32x32x16_bf16 v[144:159], v[188:191], v[92:95], v[144:159]
    buffer_load_dwordx4 v[252:255], v40, s[76:79], s10 offen offset:3072 sc1
    s_mov_b32 s10, s13
    s_mov_b32 s13, s16
    s_add_u32 s66, s66, 1
    s_cmp_lt_u32 s66, 3
    s_cbranch_scc1 L_A_g2
    s_mov_b32 s67, 0
    s_nop 0
    buffer_store_dword v128, v5, s[56:59], s67 offen offset:0 sc1
    s_nop 2
    buffer_store_dword v144, v5, s[56:59], s67 offen offset:128 sc1
    s_mov_b32 s67, 4608
    buffer_store_dword v129, v5, s[56:59], s67 offen offset:0 sc1
    buffer_store_dword v145, v5, s[56:59], s67 offen offset:128 sc1
    s_mov_b32 s67, 9216
    buffer_store_dword v130, v5, s[56:59], s67 offen offset:0 sc1
    buffer_store_dword v146, v5, s[56:59], s67 offen offset:128 sc1
    s_mov_b32 s67, 13824
    buffer_store_dword v131, v5, s[56:59], s67 offen offset:0 sc1
    buffer_store_dword v147, v5, s[56:59], s67 offen offset:128 sc1
    s_mov_b32 s67, 36864
    buffer_store_dword v132, v5, s[56:59], s67 offen offset:0 sc1
    buffer_store_dword v148, v5, s[56:59], s67 offen offset:128 sc1
    s_mov_b32 s67, 41472
    buffer_store_dword v133, v5, s[56:59], s67 offen offset:0 sc1
    buffer_store_dword v149, v5, s[56:59], s67 offen offset:128 sc1
    s_mov_b32 s67, 46080
    buffer_store_dword v134, v5, s[56:59], s67 offen offset:0 sc1
    buffer_store_dword v150, v5, s[56:59], s67 offen offset:128 sc1
    s_mov_b32 s67, 50688
    buffer_store_dword v135, v5, s[56:59], s67 offen offset:0 sc1
    buffer_store_dword v151, v5, s[56:59], s67 offen offset:128 sc1
    s_mov_b32 s67, 73728
    buffer_store_dword v136, v5, s[56:59], s67 offen offset:0 sc1
    buffer_store_dword v152, v5, s[56:59], s67 offen offset:128 sc1
    s_mov_b32 s67, 78336
    buffer_store_dword v137, v5, s[56:59], s67 offen offset:0 sc1
    buffer_store_dword v153, v5, s[56:59], s67 offen offset:128 sc1
    s_mov_b32 s67, 82944
    buffer_store_dword v138, v5, s[56:59], s67 offen offset:0 sc1
    buffer_store_dword v154, v5, s[56:59], s67 offen offset:128 sc1
    s_mov_b32 s67, 87552
    buffer_store_dword v139, v5, s[56:59], s67 offen offset:0 sc1
    buffer_store_dword v155, v5, s[56:59], s67 offen offset:128 sc1
    s_mov_b32 s67, 110592
    buffer_store_dword v140, v5, s[56:59], s67 offen offset:0 sc1
    buffer_store_dword v156, v5, s[56:59], s67 offen offset:128 sc1
    s_mov_b32 s67, 115200
    buffer_store_dword v141, v5, s[56:59], s67 offen offset:0 sc1
    buffer_store_dword v157, v5, s[56:59], s67 offen offset:128 sc1
    s_mov_b32 s67, 119808
    buffer_store_dword v142, v5, s[56:59], s67 offen offset:0 sc1
    buffer_store_dword v158, v5, s[56:59], s67 offen offset:128 sc1
    s_mov_b32 s67, 124416
    buffer_store_dword v143, v5, s[56:59], s67 offen offset:0 sc1
    buffer_store_dword v159, v5, s[56:59], s67 offen offset:128 sc1
    s_endpgm
L_B:
    s_cmp_lt_u32 s43, 30
    s_cbranch_scc1 L_B2
    s_cmp_ge_u32 s42, 2
    s_cbranch_scc1 L_B2
    s_lshl_b32 s62, s42, 1
    s_add_u32 s62, s62, s43
    s_sub_u32 s62, s62, 30
    s_lshl_b32 s62, s62, 3
    s_add_u32 s62, s62, s44
    s_mul_i32 s61, s62, 6144
    v_lshlrev_b32 v5, 4, v2
    v_add_u32 v5, s61, v5
    v_add_u32 v6, 4096, v5
    s_and_b32 s60, s43, 1
    s_lshl_b32 s60, s60, 9
    v_add_u32 v4, s60, v0
    v_mul_u32_u24 v4, 1152, v4
    v_mov_b32 v12, -1
    v_mov_b32 v13, -1
    v_mov_b32 v14, -1
    v_mov_b32 v15, -1
    s_and_b32 s63, s62, 3
    s_lshl_b32 s63, s63, 6
    v_mov_b32 v16, s63
    v_mov_b32 v17, 1
    s_waitcnt lgkmcnt(0)
    s_mov_b32 s48, s22
    s_mov_b32 s49, s23
    s_mov_b32 s50, 0x240000
    s_mov_b32 s51, 0x20000
    s_add_u32 s52, s40, 0x480000
    s_addc_u32 s53, s41, 0
    s_mov_b32 s54, 0x2d000
    s_mov_b32 s55, 0x20000
    s_mov_b32 s56, s38
    s_mov_b32 s57, s39
    s_mov_b32 s58, 0x100
    s_mov_b32 s59, 0x20000
    buffer_store_dwordx4 v[12:15], v5, s[52:55], 0 offen offset:0 sc1
    buffer_store_dwordx4 v[12:15], v5, s[52:55], 0 offen offset:1024 sc1
    buffer_store_dwordx4 v[12:15], v5, s[52:55], 0 offen offset:2048 sc1
    buffer_store_dwordx4 v[12:15], v5, s[52:55], 0 offen offset:3072 sc1
    buffer_store_dwordx4 v[12:15], v6, s[52:55], 0 offen offset:0 sc1
    buffer_store_dwordx4 v[12:15], v6, s[52:55], 0 offen offset:1024 sc1
    s_waitcnt vmcnt(0)
    s_mov_b64 exec, 1
    buffer_atomic_add v17, v16, s[56:59], 0 offen sc1
    s_mov_b64 exec, -1
    s_waitcnt vmcnt(0)
    s_mov_b32 s63, 0
    buffer_load_dword v20, v4, s[48:51], s63 offen offset:1024
    s_mov_b32 s63, 1179648
    buffer_load_dword v21, v4, s[48:51], s63 offen offset:1024
    s_endpgm
    .p2align 6
L_B2:
    s_mov_b32 s87, s44
    s_mov_b32 s86, 0
    s_lshl_b32 s45, s42, 3
    s_add_u32 s45, s45, s43
    s_sub_u32 s45, s45, 18
    s_cmp_lt_u32 s43, 26
    s_cbranch_scc1 L_B_role
    s_lshl_b32 s45, s42, 2
    s_add_u32 s45, s45, s43
    s_add_u32 s45, s45, 38
    s_cmp_lt_u32 s42, 2
    s_cbranch_scc1 L_B_role
    s_mov_b32 s86, 1
    s_mul_i32 s3, s42, 6
    s_add_u32 s3, s3, s43
    s_sub_u32 s3, s3, 38
    s_lshr_b32 s45, s3, 2
    s_lshl_b32 s45, s45, 3
    s_and_b32 s3, s3, 3
    s_add_u32 s45, s45, s3
    s_and_b32 s3, s44, 4
    s_add_u32 s45, s45, s3
    s_and_b32 s87, s44, 3
    s_add_u32 s87, s87, 4
L_B_role:
    s_lshl_b32 s46, s45, 3
    s_add_u32 s46, s46, s87
    s_mul_i32 s47, s44, 20464
    v_lshlrev_b32 v5, 3, v2
    v_add_u32 v5, s47, v5
    v_mov_b32 v7, 0xffff0000
    v_and_b32 v3, 31, v2
    v_lshrrev_b32 v4, 5, v2
    v_mov_b32 v240, 0
    v_mov_b32 v241, 0
    v_and_b32 v243, 3, v2
    v_lshlrev_b32 v243, 6, v243
    s_lshl_b32 s85, s45, 2
    s_and_b32 s84, s87, 3
    s_add_u32 s85, s85, s84
    s_lshl_b32 s76, s45, 4
    s_waitcnt lgkmcnt(0)
    s_mov_b32 s72, s36
    s_mov_b32 s73, s37
    s_mov_b32 s74, 0x900000
    s_mov_b32 s75, 0x20000
    s_add_u32 s78, s34, s76
    s_addc_u32 s79, s35, 0
    s_load_dwordx4 s[88:91], s[78:79], 0
    s_cmp_eq_u32 s86, 1
    s_cbranch_scc1 L_B_kg
    s_mov_b32 exec_hi, 0x00ffffff
    ds_write_b64 v5, v[240:241] offset:0
    ds_write_b64 v5, v[240:241] offset:4576
    s_mov_b64 exec, -1
    s_cmp_lt_u32 s44, 4
    s_cbranch_scc0 L_B_uy
L_B_kg:
    s_mov_b32 s48, s24
    s_mov_b32 s49, s25
    s_mov_b32 s50, 0x24000
    s_mov_b32 s51, 0x20000
    s_mov_b32 s52, s26
    s_mov_b32 s53, s27
    s_mov_b32 s54, 0x24000
    s_mov_b32 s55, 0x20000
    s_mov_b32 s64, s32
    s_mov_b32 s65, s33
    s_mov_b32 s66, 0x480
    s_mov_b32 s67, 0x20000
    s_lshl_b32 s77, s46, 8
    v_lshlrev_b32 v14, 2, v2
    v_add_u32 v14, s77, v14
    s_lshl_b32 s77, s46, 1
    v_mov_b32 v15, s77
    buffer_load_dword v8, v14, s[48:51], 0 offen
    buffer_load_dword v9, v14, s[52:55], 0 offen
    buffer_load_ushort v12, v15, s[64:67], 0 offen
    s_mov_b32 s56, s28
    s_mov_b32 s57, s29
    s_mov_b32 s58, 0x24000
    s_mov_b32 s59, 0x20000
    s_mov_b32 s60, s30
    s_mov_b32 s61, s31
    s_mov_b32 s62, 0x24000
    s_mov_b32 s63, 0x20000
    buffer_load_dword v10, v14, s[56:59], 0 offen
    buffer_load_dword v11, v14, s[60:63], 0 offen
    s_add_u32 s76, s47, 90976
    s_cmp_eq_u32 s86, 1
    s_cselect_b32 s76, s47, s76
    v_lshlrev_b32 v55, 3, v2
    v_add_u32 v55, s76, v55
    s_add_u32 s77, s47, 9120
    v_mov_b32 v6, s77
    v_mov_b32 v16, s76
    v_cmp_lt_u32 vcc, 15, v3
    s_nop 1
    v_cndmask_b32 v6, v6, v16, vcc
    v_and_b32 v16, 15, v3
    v_mul_u32_u24 v16, 528, v16
    v_lshl_add_u32 v16, v4, 4, v16
    v_add_u32 v6, v6, v16
    s_waitcnt vmcnt(0) lgkmcnt(0)
    v_lshlrev_b32 v12, 16, v12
    v_mul_f32 v12, 0x3fb8aa3b, v12
    v_exp_f32 v12, v12
    v_lshlrev_b32 v14, 16, v8
    v_and_b32 v15, v7, v8
    v_lshlrev_b32 v16, 16, v9
    v_and_b32 v17, v7, v9
    v_cvt_pk_bf16_f32 v12, v12, v12
    v_lshlrev_b32 v12, 16, v12
    v_mul_f32 v14, 0x3fb8aa3b, v14
    v_mul_f32 v15, 0x3fb8aa3b, v15
    v_exp_f32 v14, v14
    v_exp_f32 v15, v15
    v_mul_f32 v16, v16, v12
    v_mul_f32 v17, v17, v12
    v_cvt_pk_bf16_f32 v15, v14, v15
    v_lshlrev_b32 v14, 16, v15
    v_and_b32 v15, v7, v15
    v_mul_f32 v14, v14, v12
    v_mul_f32 v16, 0.15915494, v16
    v_mul_f32 v15, v15, v12
    v_mul_f32 v17, 0.15915494, v17
    v_mul_f32 v14, 0xbfb8aa3b, v14
    v_mul_f32 v15, 0xbfb8aa3b, v15
    v_mul_f32 v32, 0x41000000, v14
    v_mul_f32 v36, 0x41000000, v15
    v_mul_f32 v33, 0x41000000, v16
    v_mul_f32 v37, 0x41000000, v17
    v_exp_f32 v32, v32
    v_exp_f32 v36, v36
    v_rndne_f32 v34, v33
    v_rndne_f32 v38, v37
    v_sub_f32 v33, v33, v34
    v_sub_f32 v37, v37, v38
    v_cos_f32 v34, v33
    v_cos_f32 v38, v37
    v_sin_f32 v33, v33
    v_sin_f32 v37, v37
    v_mul_f32 v132, v32, v34
    v_mul_f32 v134, v36, v38
    v_mul_f32 v133, v32, v33
    v_mul_f32 v135, v36, v37
    v_mov_b32 v56, 0x00003f80
    v_mov_b32 v57, 0x00003f80
    ds_write_b64 v5, v[56:57] offset:9120
    v_pk_mul_f32 v[136:137], v[132:133], v[132:133] op_sel:[0,0] op_sel_hi:[0,1]
    v_pk_mul_f32 v[138:139], v[134:135], v[134:135] op_sel:[0,0] op_sel_hi:[0,1]
    v_pk_fma_f32 v[136:137], v[132:133], v[132:133], v[136:137] op_sel:[1,1,0] op_sel_hi:[1,0,1] neg_lo:[1,0,0]
    v_pk_fma_f32 v[138:139], v[134:135], v[134:135], v[138:139] op_sel:[1,1,0] op_sel_hi:[1,0,1] neg_lo:[1,0,0]
    v_cvt_pk_bf16_f32 v58, v132, v133
    v_cvt_pk_bf16_f32 v59, v134, v135
    ds_write_b64 v5, v[58:59] offset:9648
    v_pk_mul_f32 v[140:141], v[136:137], v[132:133] op_sel:[0,0] op_sel_hi:[0,1]
    v_pk_mul_f32 v[142:143], v[138:139], v[134:135] op_sel:[0,0] op_sel_hi:[0,1]
    v_pk_mul_f32 v[40:41], v[136:137], v[136:137] op_sel:[0,0] op_sel_hi:[0,1]
    v_pk_mul_f32 v[42:43], v[138:139], v[138:139] op_sel:[0,0] op_sel_hi:[0,1]
    v_pk_fma_f32 v[140:141], v[136:137], v[132:133], v[140:141] op_sel:[1,1,0] op_sel_hi:[1,0,1] neg_lo:[1,0,0]
    v_pk_fma_f32 v[142:143], v[138:139], v[134:135], v[142:143] op_sel:[1,1,0] op_sel_hi:[1,0,1] neg_lo:[1,0,0]
    v_pk_fma_f32 v[40:41], v[136:137], v[136:137], v[40:41] op_sel:[1,1,0] op_sel_hi:[1,0,1] neg_lo:[1,0,0]
    v_pk_fma_f32 v[42:43], v[138:139], v[138:139], v[42:43] op_sel:[1,1,0] op_sel_hi:[1,0,1] neg_lo:[1,0,0]
    v_cvt_pk_bf16_f32 v60, v136, v137
    v_cvt_pk_bf16_f32 v61, v138, v139
    ds_write_b64 v5, v[60:61] offset:10176
    v_cvt_pk_bf16_f32 v62, v140, v141
    v_cvt_pk_bf16_f32 v63, v142, v143
    ds_write_b64 v5, v[62:63] offset:10704
    v_pk_mul_f32 v[148:149], v[132:133], v[40:41] op_sel:[0,0] op_sel_hi:[0,1]
    v_pk_mul_f32 v[150:151], v[134:135], v[42:43] op_sel:[0,0] op_sel_hi:[0,1]
    v_pk_mul_f32 v[152:153], v[136:137], v[40:41] op_sel:[0,0] op_sel_hi:[0,1]
    v_pk_mul_f32 v[154:155], v[138:139], v[42:43] op_sel:[0,0] op_sel_hi:[0,1]
    v_pk_mul_f32 v[156:157], v[140:141], v[40:41] op_sel:[0,0] op_sel_hi:[0,1]
    v_pk_mul_f32 v[158:159], v[142:143], v[42:43] op_sel:[0,0] op_sel_hi:[0,1]
    v_pk_fma_f32 v[148:149], v[132:133], v[40:41], v[148:149] op_sel:[1,1,0] op_sel_hi:[1,0,1] neg_lo:[1,0,0]
    v_pk_fma_f32 v[150:151], v[134:135], v[42:43], v[150:151] op_sel:[1,1,0] op_sel_hi:[1,0,1] neg_lo:[1,0,0]
    v_pk_fma_f32 v[152:153], v[136:137], v[40:41], v[152:153] op_sel:[1,1,0] op_sel_hi:[1,0,1] neg_lo:[1,0,0]
    v_pk_fma_f32 v[154:155], v[138:139], v[42:43], v[154:155] op_sel:[1,1,0] op_sel_hi:[1,0,1] neg_lo:[1,0,0]
    v_pk_fma_f32 v[156:157], v[140:141], v[40:41], v[156:157] op_sel:[1,1,0] op_sel_hi:[1,0,1] neg_lo:[1,0,0]
    v_pk_fma_f32 v[158:159], v[142:143], v[42:43], v[158:159] op_sel:[1,1,0] op_sel_hi:[1,0,1] neg_lo:[1,0,0]
    v_cvt_pk_bf16_f32 v56, v40, v41
    v_cvt_pk_bf16_f32 v57, v42, v43
    ds_write_b64 v5, v[56:57] offset:11232
    v_cvt_pk_bf16_f32 v58, v148, v149
    v_cvt_pk_bf16_f32 v59, v150, v151
    ds_write_b64 v5, v[58:59] offset:11760
    v_cvt_pk_bf16_f32 v60, v152, v153
    v_cvt_pk_bf16_f32 v61, v154, v155
    ds_write_b64 v5, v[60:61] offset:12288
    v_cvt_pk_bf16_f32 v62, v156, v157
    v_cvt_pk_bf16_f32 v63, v158, v159
    ds_write_b64 v5, v[62:63] offset:12816
    v_pk_mul_f32 v[128:129], v[40:41], v[40:41] op_sel:[0,0] op_sel_hi:[0,1]
    v_pk_mul_f32 v[130:131], v[42:43], v[42:43] op_sel:[0,0] op_sel_hi:[0,1]
    v_pk_mul_f32 v[132:133], v[148:149], v[40:41] op_sel:[0,0] op_sel_hi:[0,1]
    v_pk_mul_f32 v[134:135], v[150:151], v[42:43] op_sel:[0,0] op_sel_hi:[0,1]
    v_pk_mul_f32 v[136:137], v[152:153], v[40:41] op_sel:[0,0] op_sel_hi:[0,1]
    v_pk_mul_f32 v[138:139], v[154:155], v[42:43] op_sel:[0,0] op_sel_hi:[0,1]
    v_pk_mul_f32 v[140:141], v[156:157], v[40:41] op_sel:[0,0] op_sel_hi:[0,1]
    v_pk_mul_f32 v[142:143], v[158:159], v[42:43] op_sel:[0,0] op_sel_hi:[0,1]
    v_pk_fma_f32 v[128:129], v[40:41], v[40:41], v[128:129] op_sel:[1,1,0] op_sel_hi:[1,0,1] neg_lo:[1,0,0]
    v_pk_fma_f32 v[130:131], v[42:43], v[42:43], v[130:131] op_sel:[1,1,0] op_sel_hi:[1,0,1] neg_lo:[1,0,0]
    v_pk_fma_f32 v[132:133], v[148:149], v[40:41], v[132:133] op_sel:[1,1,0] op_sel_hi:[1,0,1] neg_lo:[1,0,0]
    v_pk_fma_f32 v[134:135], v[150:151], v[42:43], v[134:135] op_sel:[1,1,0] op_sel_hi:[1,0,1] neg_lo:[1,0,0]
    v_pk_fma_f32 v[136:137], v[152:153], v[40:41], v[136:137] op_sel:[1,1,0] op_sel_hi:[1,0,1] neg_lo:[1,0,0]
    v_pk_fma_f32 v[138:139], v[154:155], v[42:43], v[138:139] op_sel:[1,1,0] op_sel_hi:[1,0,1] neg_lo:[1,0,0]
    v_pk_fma_f32 v[140:141], v[156:157], v[40:41], v[140:141] op_sel:[1,1,0] op_sel_hi:[1,0,1] neg_lo:[1,0,0]
    v_pk_fma_f32 v[142:143], v[158:159], v[42:43], v[142:143] op_sel:[1,1,0] op_sel_hi:[1,0,1] neg_lo:[1,0,0]
    v_cvt_pk_bf16_f32 v56, v128, v129
    v_cvt_pk_bf16_f32 v57, v130, v131
    ds_write_b64 v5, v[56:57] offset:13344
    v_cvt_pk_bf16_f32 v58, v132, v133
    v_cvt_pk_bf16_f32 v59, v134, v135
    ds_write_b64 v5, v[58:59] offset:13872
    v_cvt_pk_bf16_f32 v60, v136, v137
    v_cvt_pk_bf16_f32 v61, v138, v139
    ds_write_b64 v5, v[60:61] offset:14400
    v_cvt_pk_bf16_f32 v62, v140, v141
    v_cvt_pk_bf16_f32 v63, v142, v143
    ds_write_b64 v5, v[62:63] offset:14928
    v_pk_mul_f32 v[144:145], v[128:129], v[40:41] op_sel:[0,0] op_sel_hi:[0,1]
    v_pk_mul_f32 v[146:147], v[130:131], v[42:43] op_sel:[0,0] op_sel_hi:[0,1]
    v_pk_mul_f32 v[148:149], v[132:133], v[40:41] op_sel:[0,0] op_sel_hi:[0,1]
    v_pk_mul_f32 v[150:151], v[134:135], v[42:43] op_sel:[0,0] op_sel_hi:[0,1]
    v_pk_mul_f32 v[152:153], v[136:137], v[40:41] op_sel:[0,0] op_sel_hi:[0,1]
    v_pk_mul_f32 v[154:155], v[138:139], v[42:43] op_sel:[0,0] op_sel_hi:[0,1]
    v_pk_mul_f32 v[156:157], v[140:141], v[40:41] op_sel:[0,0] op_sel_hi:[0,1]
    v_pk_mul_f32 v[158:159], v[142:143], v[42:43] op_sel:[0,0] op_sel_hi:[0,1]
    v_pk_fma_f32 v[144:145], v[128:129], v[40:41], v[144:145] op_sel:[1,1,0] op_sel_hi:[1,0,1] neg_lo:[1,0,0]
    v_pk_fma_f32 v[146:147], v[130:131], v[42:43], v[146:147] op_sel:[1,1,0] op_sel_hi:[1,0,1] neg_lo:[1,0,0]
    v_pk_fma_f32 v[148:149], v[132:133], v[40:41], v[148:149] op_sel:[1,1,0] op_sel_hi:[1,0,1] neg_lo:[1,0,0]
    v_pk_fma_f32 v[150:151], v[134:135], v[42:43], v[150:151] op_sel:[1,1,0] op_sel_hi:[1,0,1] neg_lo:[1,0,0]
    v_pk_fma_f32 v[152:153], v[136:137], v[40:41], v[152:153] op_sel:[1,1,0] op_sel_hi:[1,0,1] neg_lo:[1,0,0]
    v_pk_fma_f32 v[154:155], v[138:139], v[42:43], v[154:155] op_sel:[1,1,0] op_sel_hi:[1,0,1] neg_lo:[1,0,0]
    v_pk_fma_f32 v[156:157], v[140:141], v[40:41], v[156:157] op_sel:[1,1,0] op_sel_hi:[1,0,1] neg_lo:[1,0,0]
    v_pk_fma_f32 v[158:159], v[142:143], v[42:43], v[158:159] op_sel:[1,1,0] op_sel_hi:[1,0,1] neg_lo:[1,0,0]
    v_cvt_pk_bf16_f32 v56, v144, v145
    v_cvt_pk_bf16_f32 v57, v146, v147
    ds_write_b64 v5, v[56:57] offset:15456
    v_cvt_pk_bf16_f32 v58, v148, v149
    v_cvt_pk_bf16_f32 v59, v150, v151
    ds_write_b64 v5, v[58:59] offset:15984
    v_cvt_pk_bf16_f32 v60, v152, v153
    v_cvt_pk_bf16_f32 v61, v154, v155
    ds_write_b64 v5, v[60:61] offset:16512
    v_cvt_pk_bf16_f32 v62, v156, v157
    v_cvt_pk_bf16_f32 v63, v158, v159
    ds_write_b64 v5, v[62:63] offset:17040
    v_pk_mul_f32 v[128:129], v[144:145], v[40:41] op_sel:[0,0] op_sel_hi:[0,1]
    v_pk_mul_f32 v[130:131], v[146:147], v[42:43] op_sel:[0,0] op_sel_hi:[0,1]
    v_pk_mul_f32 v[132:133], v[148:149], v[40:41] op_sel:[0,0] op_sel_hi:[0,1]
    v_pk_mul_f32 v[134:135], v[150:151], v[42:43] op_sel:[0,0] op_sel_hi:[0,1]
    v_pk_mul_f32 v[136:137], v[152:153], v[40:41] op_sel:[0,0] op_sel_hi:[0,1]
    v_pk_mul_f32 v[138:139], v[154:155], v[42:43] op_sel:[0,0] op_sel_hi:[0,1]
    v_pk_mul_f32 v[140:141], v[156:157], v[40:41] op_sel:[0,0] op_sel_hi:[0,1]
    v_pk_mul_f32 v[142:143], v[158:159], v[42:43] op_sel:[0,0] op_sel_hi:[0,1]
    v_pk_fma_f32 v[128:129], v[144:145], v[40:41], v[128:129] op_sel:[1,1,0] op_sel_hi:[1,0,1] neg_lo:[1,0,0]
    v_pk_fma_f32 v[130:131], v[146:147], v[42:43], v[130:131] op_sel:[1,1,0] op_sel_hi:[1,0,1] neg_lo:[1,0,0]
    v_pk_fma_f32 v[132:133], v[148:149], v[40:41], v[132:133] op_sel:[1,1,0] op_sel_hi:[1,0,1] neg_lo:[1,0,0]
    v_pk_fma_f32 v[134:135], v[150:151], v[42:43], v[134:135] op_sel:[1,1,0] op_sel_hi:[1,0,1] neg_lo:[1,0,0]
    v_pk_fma_f32 v[136:137], v[152:153], v[40:41], v[136:137] op_sel:[1,1,0] op_sel_hi:[1,0,1] neg_lo:[1,0,0]
    v_pk_fma_f32 v[138:139], v[154:155], v[42:43], v[138:139] op_sel:[1,1,0] op_sel_hi:[1,0,1] neg_lo:[1,0,0]
    v_pk_fma_f32 v[140:141], v[156:157], v[40:41], v[140:141] op_sel:[1,1,0] op_sel_hi:[1,0,1] neg_lo:[1,0,0]
    v_pk_fma_f32 v[142:143], v[158:159], v[42:43], v[142:143] op_sel:[1,1,0] op_sel_hi:[1,0,1] neg_lo:[1,0,0]
    v_cvt_pk_bf16_f32 v56, v128, v129
    v_cvt_pk_bf16_f32 v57, v130, v131
    ds_write_b64 v55, v[56:57] offset:0
    v_cvt_pk_bf16_f32 v58, v132, v133
    v_cvt_pk_bf16_f32 v59, v134, v135
    ds_write_b64 v55, v[58:59] offset:528
    v_cvt_pk_bf16_f32 v60, v136, v137
    v_cvt_pk_bf16_f32 v61, v138, v139
    ds_write_b64 v55, v[60:61] offset:1056
    v_cvt_pk_bf16_f32 v62, v140, v141
    v_cvt_pk_bf16_f32 v63, v142, v143
    ds_write_b64 v55, v[62:63] offset:1584
    v_pk_mul_f32 v[144:145], v[128:129], v[40:41] op_sel:[0,0] op_sel_hi:[0,1]
    v_pk_mul_f32 v[146:147], v[130:131], v[42:43] op_sel:[0,0] op_sel_hi:[0,1]
    v_pk_mul_f32 v[148:149], v[132:133], v[40:41] op_sel:[0,0] op_sel_hi:[0,1]
    v_pk_mul_f32 v[150:151], v[134:135], v[42:43] op_sel:[0,0] op_sel_hi:[0,1]
    v_pk_mul_f32 v[152:153], v[136:137], v[40:41] op_sel:[0,0] op_sel_hi:[0,1]
    v_pk_mul_f32 v[154:155], v[138:139], v[42:43] op_sel:[0,0] op_sel_hi:[0,1]
    v_pk_mul_f32 v[156:157], v[140:141], v[40:41] op_sel:[0,0] op_sel_hi:[0,1]
    v_pk_mul_f32 v[158:159], v[142:143], v[42:43] op_sel:[0,0] op_sel_hi:[0,1]
    v_pk_fma_f32 v[144:145], v[128:129], v[40:41], v[144:145] op_sel:[1,1,0] op_sel_hi:[1,0,1] neg_lo:[1,0,0]
    v_pk_fma_f32 v[146:147], v[130:131], v[42:43], v[146:147] op_sel:[1,1,0] op_sel_hi:[1,0,1] neg_lo:[1,0,0]
    v_pk_fma_f32 v[148:149], v[132:133], v[40:41], v[148:149] op_sel:[1,1,0] op_sel_hi:[1,0,1] neg_lo:[1,0,0]
    v_pk_fma_f32 v[150:151], v[134:135], v[42:43], v[150:151] op_sel:[1,1,0] op_sel_hi:[1,0,1] neg_lo:[1,0,0]
    v_pk_fma_f32 v[152:153], v[136:137], v[40:41], v[152:153] op_sel:[1,1,0] op_sel_hi:[1,0,1] neg_lo:[1,0,0]
    v_pk_fma_f32 v[154:155], v[138:139], v[42:43], v[154:155] op_sel:[1,1,0] op_sel_hi:[1,0,1] neg_lo:[1,0,0]
    v_pk_fma_f32 v[156:157], v[140:141], v[40:41], v[156:157] op_sel:[1,1,0] op_sel_hi:[1,0,1] neg_lo:[1,0,0]
    v_pk_fma_f32 v[158:159], v[142:143], v[42:43], v[158:159] op_sel:[1,1,0] op_sel_hi:[1,0,1] neg_lo:[1,0,0]
    v_cvt_pk_bf16_f32 v56, v144, v145
    v_cvt_pk_bf16_f32 v57, v146, v147
    ds_write_b64 v55, v[56:57] offset:2112
    v_cvt_pk_bf16_f32 v58, v148, v149
    v_cvt_pk_bf16_f32 v59, v150, v151
    ds_write_b64 v55, v[58:59] offset:2640
    v_cvt_pk_bf16_f32 v60, v152, v153
    v_cvt_pk_bf16_f32 v61, v154, v155
    ds_write_b64 v55, v[60:61] offset:3168
    v_cvt_pk_bf16_f32 v62, v156, v157
    v_cvt_pk_bf16_f32 v63, v158, v159
    ds_write_b64 v55, v[62:63] offset:3696
    v_pk_mul_f32 v[128:129], v[144:145], v[40:41] op_sel:[0,0] op_sel_hi:[0,1]
    v_pk_mul_f32 v[130:131], v[146:147], v[42:43] op_sel:[0,0] op_sel_hi:[0,1]
    v_pk_mul_f32 v[132:133], v[148:149], v[40:41] op_sel:[0,0] op_sel_hi:[0,1]
    v_pk_mul_f32 v[134:135], v[150:151], v[42:43] op_sel:[0,0] op_sel_hi:[0,1]
    v_pk_mul_f32 v[136:137], v[152:153], v[40:41] op_sel:[0,0] op_sel_hi:[0,1]
    v_pk_mul_f32 v[138:139], v[154:155], v[42:43] op_sel:[0,0] op_sel_hi:[0,1]
    v_pk_mul_f32 v[140:141], v[156:157], v[40:41] op_sel:[0,0] op_sel_hi:[0,1]
    v_pk_mul_f32 v[142:143], v[158:159], v[42:43] op_sel:[0,0] op_sel_hi:[0,1]
    v_pk_fma_f32 v[128:129], v[144:145], v[40:41], v[128:129] op_sel:[1,1,0] op_sel_hi:[1,0,1] neg_lo:[1,0,0]
    v_pk_fma_f32 v[130:131], v[146:147], v[42:43], v[130:131] op_sel:[1,1,0] op_sel_hi:[1,0,1] neg_lo:[1,0,0]
    v_pk_fma_f32 v[132:133], v[148:149], v[40:41], v[132:133] op_sel:[1,1,0] op_sel_hi:[1,0,1] neg_lo:[1,0,0]
    v_pk_fma_f32 v[134:135], v[150:151], v[42:43], v[134:135] op_sel:[1,1,0] op_sel_hi:[1,0,1] neg_lo:[1,0,0]
    v_pk_fma_f32 v[136:137], v[152:153], v[40:41], v[136:137] op_sel:[1,1,0] op_sel_hi:[1,0,1] neg_lo:[1,0,0]
    v_pk_fma_f32 v[138:139], v[154:155], v[42:43], v[138:139] op_sel:[1,1,0] op_sel_hi:[1,0,1] neg_lo:[1,0,0]
    v_pk_fma_f32 v[140:141], v[156:157], v[40:41], v[140:141] op_sel:[1,1,0] op_sel_hi:[1,0,1] neg_lo:[1,0,0]
    v_pk_fma_f32 v[142:143], v[158:159], v[42:43], v[142:143] op_sel:[1,1,0] op_sel_hi:[1,0,1] neg_lo:[1,0,0]
    v_cvt_pk_bf16_f32 v56, v128, v129
    v_cvt_pk_bf16_f32 v57, v130, v131
    ds_write_b64 v55, v[56:57] offset:4224
    v_cvt_pk_bf16_f32 v58, v132, v133
    v_cvt_pk_bf16_f32 v59, v134, v135
    ds_write_b64 v55, v[58:59] offset:4752
    v_cvt_pk_bf16_f32 v60, v136, v137
    v_cvt_pk_bf16_f32 v61, v138, v139
    ds_write_b64 v55, v[60:61] offset:5280
    v_cvt_pk_bf16_f32 v62, v140, v141
    v_cvt_pk_bf16_f32 v63, v142, v143
    ds_write_b64 v55, v[62:63] offset:5808
    v_pk_mul_f32 v[144:145], v[128:129], v[40:41] op_sel:[0,0] op_sel_hi:[0,1]
    v_pk_mul_f32 v[146:147], v[130:131], v[42:43] op_sel:[0,0] op_sel_hi:[0,1]
    v_pk_mul_f32 v[148:149], v[132:133], v[40:41] op_sel:[0,0] op_sel_hi:[0,1]
    v_pk_mul_f32 v[150:151], v[134:135], v[42:43] op_sel:[0,0] op_sel_hi:[0,1]
    v_pk_mul_f32 v[152:153], v[136:137], v[40:41] op_sel:[0,0] op_sel_hi:[0,1]
    v_pk_mul_f32 v[154:155], v[138:139], v[42:43] op_sel:[0,0] op_sel_hi:[0,1]
    v_pk_mul_f32 v[156:157], v[140:141], v[40:41] op_sel:[0,0] op_sel_hi:[0,1]
    v_pk_mul_f32 v[158:159], v[142:143], v[42:43] op_sel:[0,0] op_sel_hi:[0,1]
    v_pk_fma_f32 v[144:145], v[128:129], v[40:41], v[144:145] op_sel:[1,1,0] op_sel_hi:[1,0,1] neg_lo:[1,0,0]
    v_pk_fma_f32 v[146:147], v[130:131], v[42:43], v[146:147] op_sel:[1,1,0] op_sel_hi:[1,0,1] neg_lo:[1,0,0]
    v_pk_fma_f32 v[148:149], v[132:133], v[40:41], v[148:149] op_sel:[1,1,0] op_sel_hi:[1,0,1] neg_lo:[1,0,0]
    v_pk_fma_f32 v[150:151], v[134:135], v[42:43], v[150:151] op_sel:[1,1,0] op_sel_hi:[1,0,1] neg_lo:[1,0,0]
    v_pk_fma_f32 v[152:153], v[136:137], v[40:41], v[152:153] op_sel:[1,1,0] op_sel_hi:[1,0,1] neg_lo:[1,0,0]
    v_pk_fma_f32 v[154:155], v[138:139], v[42:43], v[154:155] op_sel:[1,1,0] op_sel_hi:[1,0,1] neg_lo:[1,0,0]
    v_pk_fma_f32 v[156:157], v[140:141], v[40:41], v[156:157] op_sel:[1,1,0] op_sel_hi:[1,0,1] neg_lo:[1,0,0]
    v_pk_fma_f32 v[158:159], v[142:143], v[42:43], v[158:159] op_sel:[1,1,0] op_sel_hi:[1,0,1] neg_lo:[1,0,0]
    v_cvt_pk_bf16_f32 v56, v144, v145
    v_cvt_pk_bf16_f32 v57, v146, v147
    ds_write_b64 v55, v[56:57] offset:6336
    v_cvt_pk_bf16_f32 v58, v148, v149
    v_cvt_pk_bf16_f32 v59, v150, v151
    ds_write_b64 v55, v[58:59] offset:6864
    v_cvt_pk_bf16_f32 v60, v152, v153
    v_cvt_pk_bf16_f32 v61, v154, v155
    ds_write_b64 v55, v[60:61] offset:7392
    v_cvt_pk_bf16_f32 v62, v156, v157
    v_cvt_pk_bf16_f32 v63, v158, v159
    ds_write_b64 v55, v[62:63] offset:7920
    ds_read_b128 v[64:67], v6 offset:0
    ds_read_b128 v[68:71], v6 offset:32
    ds_read_b128 v[72:75], v6 offset:64
    ds_read_b128 v[76:79], v6 offset:96
    ds_read_b128 v[80:83], v6 offset:128
    ds_read_b128 v[84:87], v6 offset:160
    ds_read_b128 v[88:91], v6 offset:192
    ds_read_b128 v[92:95], v6 offset:224
    ds_read_b128 v[96:99], v6 offset:256
    ds_read_b128 v[100:103], v6 offset:288
    ds_read_b128 v[104:107], v6 offset:320
    ds_read_b128 v[108:111], v6 offset:352
    ds_read_b128 v[112:115], v6 offset:384
    ds_read_b128 v[116:119], v6 offset:416
    ds_read_b128 v[120:123], v6 offset:448
    ds_read_b128 v[124:127], v6 offset:480
    v_exp_f32 v32, v14
    v_exp_f32 v36, v15
    v_rndne_f32 v34, v16
    v_rndne_f32 v38, v17
    v_sub_f32 v33, v16, v34
    v_sub_f32 v37, v17, v38
    v_cos_f32 v34, v33
    v_cos_f32 v38, v37
    v_sin_f32 v33, v33
    v_sin_f32 v37, v37
    v_mul_f32 v20, v32, v34
    v_mul_f32 v22, v36, v38
    v_mul_f32 v21, v32, v33
    v_mul_f32 v23, v36, v37
    v_mul_f32 v32, 0x43800000, v14
    v_mul_f32 v36, 0x43800000, v15
    v_mul_f32 v33, 0x43800000, v16
    v_mul_f32 v37, 0x43800000, v17
    v_exp_f32 v32, v32
    v_exp_f32 v36, v36
    v_rndne_f32 v34, v33
    v_rndne_f32 v38, v37
    v_sub_f32 v33, v33, v34
    v_sub_f32 v37, v37, v38
    v_cos_f32 v34, v33
    v_cos_f32 v38, v37
    v_sin_f32 v33, v33
    v_sin_f32 v37, v37
    v_mul_f32 v28, v32, v34
    v_mul_f32 v30, v36, v38
    v_mul_f32 v29, v32, v33
    v_mul_f32 v31, v36, v37
    v_lshrrev_b32 v14, 3, v3
    v_and_b32 v15, 3, v3
    v_lshl_add_u32 v14, v14, 2, v15
    v_bfe_u32 v15, v3, 2, 1
    v_lshlrev_b32 v16, 1, v14
    v_mov_b32 v17, 0xfa90
    v_lshrrev_b32 v17, v16, v17
    v_and_b32 v17, 3, v17
    v_add_u32 v17, 8, v17
    v_cmp_eq_u32 vcc, 1, v15
    s_nop 1
    v_cndmask_b32 v17, v14, v17, vcc
    v_add3_u32 v16, v16, v15, -4
    v_min_u32 v16, 20, v16
    v_cmp_gt_u32 vcc, 8, v14
    s_nop 1
    v_cndmask_b32 v17, v16, v17, vcc
    v_mul_u32_u24 v19, 528, v17
    v_lshl_add_u32 v19, v4, 4, v19
    v_add_u32 v19, s47, v19
    s_mov_b32 s48, s38
    s_mov_b32 s49, s39
    s_mov_b32 s50, 0x100
    s_mov_b32 s51, 0x20000
    s_cmp_eq_u32 s86, 0
    s_cbranch_scc1 L_B_noctr
    buffer_load_dword v242, v243, s[48:51], 0 offen sc1
L_B_noctr:
    v_add_f32 v13, v12, v12
    v_lshlrev_b32 v128, 16, v10
    v_lshlrev_b32 v129, 16, v11
    v_and_b32 v130, v7, v10
    v_and_b32 v131, v7, v11
    v_mul_f32 v128, v13, v128
    v_mul_f32 v130, v13, v130
    v_mul_f32 v129, -v13, v129
    v_mul_f32 v131, -v13, v131
    v_pk_mul_f32 v[44:45], v[20:21], v[20:21] op_sel:[0,0] op_sel_hi:[0,1]
    v_pk_mul_f32 v[46:47], v[22:23], v[22:23] op_sel:[0,0] op_sel_hi:[0,1]
    v_pk_mul_f32 v[40:41], v[28:29], v[28:29] op_sel:[0,0] op_sel_hi:[0,1]
    v_pk_mul_f32 v[42:43], v[30:31], v[30:31] op_sel:[0,0] op_sel_hi:[0,1]
    v_pk_fma_f32 v[44:45], v[20:21], v[20:21], v[44:45] op_sel:[1,1,0] op_sel_hi:[1,0,1] neg_lo:[1,0,0]
    v_pk_fma_f32 v[46:47], v[22:23], v[22:23], v[46:47] op_sel:[1,1,0] op_sel_hi:[1,0,1] neg_lo:[1,0,0]
    v_pk_fma_f32 v[40:41], v[28:29], v[28:29], v[40:41] op_sel:[1,1,0] op_sel_hi:[1,0,1] neg_lo:[1,0,0]
    v_pk_fma_f32 v[42:43], v[30:31], v[30:31], v[42:43] op_sel:[1,1,0] op_sel_hi:[1,0,1] neg_lo:[1,0,0]
    v_pk_mul_f32 v[132:133], v[128:129], v[20:21] op_sel:[0,0] op_sel_hi:[0,1] neg_hi:[1,0]
    v_pk_mul_f32 v[134:135], v[130:131], v[22:23] op_sel:[0,0] op_sel_hi:[0,1] neg_hi:[1,0]
    v_pk_mul_f32 v[136:137], v[128:129], v[44:45] op_sel:[0,0] op_sel_hi:[0,1] neg_hi:[1,0]
    v_pk_mul_f32 v[138:139], v[130:131], v[46:47] op_sel:[0,0] op_sel_hi:[0,1] neg_hi:[1,0]
    v_pk_mul_f32 v[160:161], v[128:129], v[28:29] op_sel:[0,0] op_sel_hi:[0,1] neg_hi:[1,0]
    v_pk_mul_f32 v[162:163], v[130:131], v[30:31] op_sel:[0,0] op_sel_hi:[0,1] neg_hi:[1,0]
    v_pk_mul_f32 v[164:165], v[128:129], v[40:41] op_sel:[0,0] op_sel_hi:[0,1] neg_hi:[1,0]
    v_pk_mul_f32 v[166:167], v[130:131], v[42:43] op_sel:[0,0] op_sel_hi:[0,1] neg_hi:[1,0]
    v_pk_fma_f32 v[132:133], v[128:129], v[20:21], v[132:133] op_sel:[1,1,0] op_sel_hi:[1,0,1]
    v_pk_fma_f32 v[134:135], v[130:131], v[22:23], v[134:135] op_sel:[1,1,0] op_sel_hi:[1,0,1]
    v_pk_fma_f32 v[136:137], v[128:129], v[44:45], v[136:137] op_sel:[1,1,0] op_sel_hi:[1,0,1]
    v_pk_fma_f32 v[138:139], v[130:131], v[46:47], v[138:139] op_sel:[1,1,0] op_sel_hi:[1,0,1]
    v_pk_fma_f32 v[160:161], v[128:129], v[28:29], v[160:161] op_sel:[1,1,0] op_sel_hi:[1,0,1]
    v_pk_fma_f32 v[162:163], v[130:131], v[30:31], v[162:163] op_sel:[1,1,0] op_sel_hi:[1,0,1]
    v_pk_fma_f32 v[164:165], v[128:129], v[40:41], v[164:165] op_sel:[1,1,0] op_sel_hi:[1,0,1]
    v_pk_fma_f32 v[166:167], v[130:131], v[42:43], v[166:167] op_sel:[1,1,0] op_sel_hi:[1,0,1]
    v_cvt_pk_bf16_f32 v56, v128, v129
    v_cvt_pk_bf16_f32 v57, v130, v131
    ds_write_b64 v5, v[56:57] offset:9120
    v_pk_mul_f32 v[140:141], v[132:133], v[44:45] op_sel:[0,0] op_sel_hi:[0,1] neg_hi:[1,0]
    v_pk_mul_f32 v[142:143], v[134:135], v[46:47] op_sel:[0,0] op_sel_hi:[0,1] neg_hi:[1,0]
    v_pk_mul_f32 v[144:145], v[136:137], v[44:45] op_sel:[0,0] op_sel_hi:[0,1] neg_hi:[1,0]
    v_pk_mul_f32 v[146:147], v[138:139], v[46:47] op_sel:[0,0] op_sel_hi:[0,1] neg_hi:[1,0]
    v_pk_mul_f32 v[168:169], v[160:161], v[40:41] op_sel:[0,0] op_sel_hi:[0,1] neg_hi:[1,0]
    v_pk_mul_f32 v[170:171], v[162:163], v[42:43] op_sel:[0,0] op_sel_hi:[0,1] neg_hi:[1,0]
    v_pk_mul_f32 v[172:173], v[164:165], v[40:41] op_sel:[0,0] op_sel_hi:[0,1] neg_hi:[1,0]
    v_pk_mul_f32 v[174:175], v[166:167], v[42:43] op_sel:[0,0] op_sel_hi:[0,1] neg_hi:[1,0]
    v_pk_fma_f32 v[140:141], v[132:133], v[44:45], v[140:141] op_sel:[1,1,0] op_sel_hi:[1,0,1]
    v_pk_fma_f32 v[142:143], v[134:135], v[46:47], v[142:143] op_sel:[1,1,0] op_sel_hi:[1,0,1]
    v_pk_fma_f32 v[144:145], v[136:137], v[44:45], v[144:145] op_sel:[1,1,0] op_sel_hi:[1,0,1]
    v_pk_fma_f32 v[146:147], v[138:139], v[46:47], v[146:147] op_sel:[1,1,0] op_sel_hi:[1,0,1]
    v_pk_fma_f32 v[168:169], v[160:161], v[40:41], v[168:169] op_sel:[1,1,0] op_sel_hi:[1,0,1]
    v_pk_fma_f32 v[170:171], v[162:163], v[42:43], v[170:171] op_sel:[1,1,0] op_sel_hi:[1,0,1]
    v_pk_fma_f32 v[172:173], v[164:165], v[40:41], v[172:173] op_sel:[1,1,0] op_sel_hi:[1,0,1]
    v_pk_fma_f32 v[174:175], v[166:167], v[42:43], v[174:175] op_sel:[1,1,0] op_sel_hi:[1,0,1]
    v_cvt_pk_bf16_f32 v58, v132, v133
    v_cvt_pk_bf16_f32 v59, v134, v135
    ds_write_b64 v5, v[58:59] offset:9648
    v_cvt_pk_bf16_f32 v60, v160, v161
    v_cvt_pk_bf16_f32 v61, v162, v163
    ds_write_b64 v5, v[60:61] offset:13344
    v_cvt_pk_bf16_f32 v62, v164, v165
    v_cvt_pk_bf16_f32 v63, v166, v167
    ds_write_b64 v5, v[62:63] offset:15456
    v_pk_mul_f32 v[148:149], v[140:141], v[44:45] op_sel:[0,0] op_sel_hi:[0,1] neg_hi:[1,0]
    v_pk_mul_f32 v[150:151], v[142:143], v[46:47] op_sel:[0,0] op_sel_hi:[0,1] neg_hi:[1,0]
    v_pk_mul_f32 v[152:153], v[144:145], v[44:45] op_sel:[0,0] op_sel_hi:[0,1] neg_hi:[1,0]
    v_pk_mul_f32 v[154:155], v[146:147], v[46:47] op_sel:[0,0] op_sel_hi:[0,1] neg_hi:[1,0]
    v_pk_mul_f32 v[176:177], v[136:137], v[28:29] op_sel:[0,0] op_sel_hi:[0,1] neg_hi:[1,0]
    v_pk_mul_f32 v[178:179], v[138:139], v[30:31] op_sel:[0,0] op_sel_hi:[0,1] neg_hi:[1,0]
    v_pk_mul_f32 v[180:181], v[168:169], v[40:41] op_sel:[0,0] op_sel_hi:[0,1] neg_hi:[1,0]
    v_pk_mul_f32 v[182:183], v[170:171], v[42:43] op_sel:[0,0] op_sel_hi:[0,1] neg_hi:[1,0]
    v_pk_mul_f32 v[184:185], v[172:173], v[40:41] op_sel:[0,0] op_sel_hi:[0,1] neg_hi:[1,0]
    v_pk_mul_f32 v[186:187], v[174:175], v[42:43] op_sel:[0,0] op_sel_hi:[0,1] neg_hi:[1,0]
    v_pk_mul_f32 v[188:189], v[144:145], v[28:29] op_sel:[0,0] op_sel_hi:[0,1] neg_hi:[1,0]
    v_pk_mul_f32 v[190:191], v[146:147], v[30:31] op_sel:[0,0] op_sel_hi:[0,1] neg_hi:[1,0]
    v_pk_fma_f32 v[148:149], v[140:141], v[44:45], v[148:149] op_sel:[1,1,0] op_sel_hi:[1,0,1]
    v_pk_fma_f32 v[150:151], v[142:143], v[46:47], v[150:151] op_sel:[1,1,0] op_sel_hi:[1,0,1]
    v_pk_fma_f32 v[152:153], v[144:145], v[44:45], v[152:153] op_sel:[1,1,0] op_sel_hi:[1,0,1]
    v_pk_fma_f32 v[154:155], v[146:147], v[46:47], v[154:155] op_sel:[1,1,0] op_sel_hi:[1,0,1]
    v_pk_fma_f32 v[176:177], v[136:137], v[28:29], v[176:177] op_sel:[1,1,0] op_sel_hi:[1,0,1]
    v_pk_fma_f32 v[178:179], v[138:139], v[30:31], v[178:179] op_sel:[1,1,0] op_sel_hi:[1,0,1]
    v_pk_fma_f32 v[180:181], v[168:169], v[40:41], v[180:181] op_sel:[1,1,0] op_sel_hi:[1,0,1]
    v_pk_fma_f32 v[182:183], v[170:171], v[42:43], v[182:183] op_sel:[1,1,0] op_sel_hi:[1,0,1]
    v_pk_fma_f32 v[184:185], v[172:173], v[40:41], v[184:185] op_sel:[1,1,0] op_sel_hi:[1,0,1]
    v_pk_fma_f32 v[186:187], v[174:175], v[42:43], v[186:187] op_sel:[1,1,0] op_sel_hi:[1,0,1]
    v_pk_fma_f32 v[188:189], v[144:145], v[28:29], v[188:189] op_sel:[1,1,0] op_sel_hi:[1,0,1]
    v_pk_fma_f32 v[190:191], v[146:147], v[30:31], v[190:191] op_sel:[1,1,0] op_sel_hi:[1,0,1]
    v_cvt_pk_bf16_f32 v56, v136, v137
    v_cvt_pk_bf16_f32 v57, v138, v139
    ds_write_b64 v5, v[56:57] offset:10176
    v_cvt_pk_bf16_f32 v58, v140, v141
    v_cvt_pk_bf16_f32 v59, v142, v143
    ds_write_b64 v5, v[58:59] offset:10704
    v_cvt_pk_bf16_f32 v60, v168, v169
    v_cvt_pk_bf16_f32 v61, v170, v171
    ds_write_b64 v5, v[60:61] offset:15984
    v_cvt_pk_bf16_f32 v62, v172, v173
    v_cvt_pk_bf16_f32 v63, v174, v175
    ds_write_b64 v5, v[62:63] offset:17568
    v_pk_mul_f32 v[156:157], v[148:149], v[44:45] op_sel:[0,0] op_sel_hi:[0,1] neg_hi:[1,0]
    v_pk_mul_f32 v[158:159], v[150:151], v[46:47] op_sel:[0,0] op_sel_hi:[0,1] neg_hi:[1,0]
    v_pk_mul_f32 v[128:129], v[144:145], v[40:41] op_sel:[0,0] op_sel_hi:[0,1] neg_hi:[1,0]
    v_pk_mul_f32 v[130:131], v[146:147], v[42:43] op_sel:[0,0] op_sel_hi:[0,1] neg_hi:[1,0]
    v_pk_mul_f32 v[132:133], v[152:153], v[28:29] op_sel:[0,0] op_sel_hi:[0,1] neg_hi:[1,0]
    v_pk_mul_f32 v[134:135], v[154:155], v[30:31] op_sel:[0,0] op_sel_hi:[0,1] neg_hi:[1,0]
    v_pk_mul_f32 v[136:137], v[180:181], v[40:41] op_sel:[0,0] op_sel_hi:[0,1] neg_hi:[1,0]
    v_pk_mul_f32 v[138:139], v[182:183], v[42:43] op_sel:[0,0] op_sel_hi:[0,1] neg_hi:[1,0]
    v_pk_mul_f32 v[140:141], v[184:185], v[40:41] op_sel:[0,0] op_sel_hi:[0,1] neg_hi:[1,0]
    v_pk_mul_f32 v[142:143], v[186:187], v[42:43] op_sel:[0,0] op_sel_hi:[0,1] neg_hi:[1,0]
    v_pk_mul_f32 v[160:161], v[188:189], v[40:41] op_sel:[0,0] op_sel_hi:[0,1] neg_hi:[1,0]
    v_pk_mul_f32 v[162:163], v[190:191], v[42:43] op_sel:[0,0] op_sel_hi:[0,1] neg_hi:[1,0]
    v_pk_fma_f32 v[156:157], v[148:149], v[44:45], v[156:157] op_sel:[1,1,0] op_sel_hi:[1,0,1]
    v_pk_fma_f32 v[158:159], v[150:151], v[46:47], v[158:159] op_sel:[1,1,0] op_sel_hi:[1,0,1]
    v_pk_fma_f32 v[128:129], v[144:145], v[40:41], v[128:129] op_sel:[1,1,0] op_sel_hi:[1,0,1]
    v_pk_fma_f32 v[130:131], v[146:147], v[42:43], v[130:131] op_sel:[1,1,0] op_sel_hi:[1,0,1]
    v_pk_fma_f32 v[132:133], v[152:153], v[28:29], v[132:133] op_sel:[1,1,0] op_sel_hi:[1,0,1]
    v_pk_fma_f32 v[134:135], v[154:155], v[30:31], v[134:135] op_sel:[1,1,0] op_sel_hi:[1,0,1]
    v_pk_fma_f32 v[136:137], v[180:181], v[40:41], v[136:137] op_sel:[1,1,0] op_sel_hi:[1,0,1]
    v_pk_fma_f32 v[138:139], v[182:183], v[42:43], v[138:139] op_sel:[1,1,0] op_sel_hi:[1,0,1]
    v_pk_fma_f32 v[140:141], v[184:185], v[40:41], v[140:141] op_sel:[1,1,0] op_sel_hi:[1,0,1]
    v_pk_fma_f32 v[142:143], v[186:187], v[42:43], v[142:143] op_sel:[1,1,0] op_sel_hi:[1,0,1]
    v_pk_fma_f32 v[160:161], v[188:189], v[40:41], v[160:161] op_sel:[1,1,0] op_sel_hi:[1,0,1]
    v_pk_fma_f32 v[162:163], v[190:191], v[42:43], v[162:163] op_sel:[1,1,0] op_sel_hi:[1,0,1]
    v_cvt_pk_bf16_f32 v56, v144, v145
    v_cvt_pk_bf16_f32 v57, v146, v147
    ds_write_b64 v5, v[56:57] offset:11232
    v_cvt_pk_bf16_f32 v58, v148, v149
    v_cvt_pk_bf16_f32 v59, v150, v151
    ds_write_b64 v5, v[58:59] offset:11760
    v_cvt_pk_bf16_f32 v60, v152, v153
    v_cvt_pk_bf16_f32 v61, v154, v155
    ds_write_b64 v5, v[60:61] offset:12288
    v_cvt_pk_bf16_f32 v62, v176, v177
    v_cvt_pk_bf16_f32 v63, v178, v179
    ds_write_b64 v5, v[62:63] offset:13872
    v_cvt_pk_bf16_f32 v56, v180, v181
    v_cvt_pk_bf16_f32 v57, v182, v183
    ds_write_b64 v5, v[56:57] offset:18096
    v_cvt_pk_bf16_f32 v58, v184, v185
    v_cvt_pk_bf16_f32 v59, v186, v187
    ds_write_b64 v5, v[58:59] offset:18624
    v_cvt_pk_bf16_f32 v60, v188, v189
    v_cvt_pk_bf16_f32 v61, v190, v191
    ds_write_b64 v5, v[60:61] offset:14400
    v_cvt_pk_bf16_f32 v62, v156, v157
    v_cvt_pk_bf16_f32 v63, v158, v159
    ds_write_b64 v5, v[62:63] offset:12816
    v_cvt_pk_bf16_f32 v56, v128, v129
    v_cvt_pk_bf16_f32 v57, v130, v131
    ds_write_b64 v5, v[56:57] offset:16512
    v_cvt_pk_bf16_f32 v58, v132, v133
    v_cvt_pk_bf16_f32 v59, v134, v135
    ds_write_b64 v5, v[58:59] offset:14928
    v_cvt_pk_bf16_f32 v60, v136, v137
    v_cvt_pk_bf16_f32 v61, v138, v139
    ds_write_b64 v5, v[60:61] offset:19152
    v_cvt_pk_bf16_f32 v62, v140, v141
    v_cvt_pk_bf16_f32 v63, v142, v143
    ds_write_b64 v5, v[62:63] offset:19680
    v_cvt_pk_bf16_f32 v56, v160, v161
    v_cvt_pk_bf16_f32 v57, v162, v163
    ds_write_b64 v5, v[56:57] offset:17040
    ds_read_b128 v[128:131], v19 offset:9120
    ds_read_b128 v[132:135], v19 offset:9152
    ds_read_b128 v[136:139], v19 offset:9184
    ds_read_b128 v[140:143], v19 offset:9216
    ds_read_b128 v[144:147], v19 offset:9248
    ds_read_b128 v[148:151], v19 offset:9280
    ds_read_b128 v[152:155], v19 offset:9312
    ds_read_b128 v[156:159], v19 offset:9344
    ds_read_b128 v[160:163], v19 offset:9376
    ds_read_b128 v[164:167], v19 offset:9408
    ds_read_b128 v[168:171], v19 offset:9440
    ds_read_b128 v[172:175], v19 offset:9472
    ds_read_b128 v[176:179], v19 offset:9504
    ds_read_b128 v[180:183], v19 offset:9536
    ds_read_b128 v[184:187], v19 offset:9568
    ds_read_b128 v[188:191], v19 offset:9600
    s_waitcnt lgkmcnt(14)
    v_mfma_f32_32x32x16_bf16 v[192:207], v[128:131], v[64:67], 0
    v_and_b32 v13, 1, v2
    v_cmp_eq_u32 s[78:79], 1, v13
    s_waitcnt lgkmcnt(14)
    v_mfma_f32_32x32x16_bf16 v[192:207], v[132:135], v[68:71], v[192:207]
    v_mul_u32_u24 v14, 81856, v13
    v_lshrrev_b32 v10, 1, v0
    s_waitcnt lgkmcnt(13)
    v_mfma_f32_32x32x16_bf16 v[192:207], v[136:139], v[72:75], v[192:207]
    v_lshl_add_u32 v14, v10, 4, v14
    v_add_u32 v14, 5024, v14
    s_waitcnt lgkmcnt(12)
    v_mfma_f32_32x32x16_bf16 v[192:207], v[140:143], v[76:79], v[192:207]
    v_lshlrev_b32 v15, 4, v2
    v_sub_u32 v15, 1008, v15
    s_waitcnt lgkmcnt(11)
    v_mfma_f32_32x32x16_bf16 v[192:207], v[144:147], v[80:83], v[192:207]
    v_add_u32 v15, s47, v15
    v_bfe_u32 v3, v2, 1, 3
    s_waitcnt lgkmcnt(10)
    v_mfma_f32_32x32x16_bf16 v[192:207], v[148:151], v[84:87], v[192:207]
    v_lshrrev_b32 v16, 4, v2
    v_mul_u32_u24 v12, 4224, v13
    s_waitcnt lgkmcnt(9)
    v_mfma_f32_32x32x16_bf16 v[192:207], v[152:155], v[88:91], v[192:207]
    v_lshl_add_u32 v12, v16, 4, v12
    v_lshlrev_b32 v17, 3, v3
    s_waitcnt lgkmcnt(8)
    v_mfma_f32_32x32x16_bf16 v[192:207], v[156:159], v[92:95], v[192:207]
    v_sub_u32 v12, v12, v17
    v_add_u32 v12, 9176, v12
    s_waitcnt lgkmcnt(7)
    v_mfma_f32_32x32x16_bf16 v[192:207], v[160:163], v[96:99], v[192:207]
    v_add_u32 v12, s47, v12
    v_and_b32 v3, 7, v2
    s_waitcnt lgkmcnt(6)
    v_mfma_f32_32x32x16_bf16 v[192:207], v[164:167], v[100:103], v[192:207]
    v_bfe_u32 v4, v2, 3, 1
    v_mul_u32_u24 v13, 4576, v4
    s_waitcnt lgkmcnt(5)
    v_mfma_f32_32x32x16_bf16 v[192:207], v[168:171], v[104:107], v[192:207]
    v_lshl_add_u32 v13, v16, 4, v13
    v_lshl_add_u32 v13, v3, 6, v13
    s_waitcnt lgkmcnt(4)
    v_mfma_f32_32x32x16_bf16 v[192:207], v[172:175], v[108:111], v[192:207]
    v_add_u32 v13, s47, v13
    v_lshrrev_b32 v17, 1, v3
    s_waitcnt lgkmcnt(3)
    v_mfma_f32_32x32x16_bf16 v[192:207], v[176:179], v[112:115], v[192:207]
    v_lshl_add_u32 v18, v3, 1, v17
    v_lshlrev_b32 v18, 3, v18
    s_waitcnt lgkmcnt(2)
    v_mfma_f32_32x32x16_bf16 v[192:207], v[180:183], v[116:119], v[192:207]
    v_lshl_add_u32 v18, v16, 2, v18
    v_add_u32 v18, v18, v4
    s_waitcnt lgkmcnt(1)
    v_mfma_f32_32x32x16_bf16 v[192:207], v[184:187], v[120:123], v[192:207]
    v_lshlrev_b32 v18, 2, v18
    v_add_u32 v18, s47, v18
    s_waitcnt lgkmcnt(0)
    v_mfma_f32_32x32x16_bf16 v[192:207], v[188:191], v[124:127], v[192:207]
    s_cmp_eq_u32 s86, 1
    s_cbranch_scc0 L_B_expand
    s_add_u32 s52, s40, 0x4c0000
    s_addc_u32 s53, s41, 0
    s_mov_b32 s54, 0x120000
    s_mov_b32 s55, 0x20000
    s_add_u32 s56, s40, 0x4a8800
    s_addc_u32 s57, s41, 0
    s_mov_b32 s58, 0x4800
    s_mov_b32 s59, 0x20000
    s_lshl_b32 s76, s85, 12
    v_lshlrev_b32 v20, 4, v2
    v_add_u32 v20, s76, v20
    s_lshl_b32 s76, s85, 6
    v_mov_b32 v21, s76
    buffer_store_dwordx4 v[192:195], v20, s[52:55], 0 offen offset:0 sc1
    buffer_store_dwordx4 v[196:199], v20, s[52:55], 0 offen offset:1024 sc1
    buffer_store_dwordx4 v[200:203], v20, s[52:55], 0 offen offset:2048 sc1
    buffer_store_dwordx4 v[204:207], v20, s[52:55], 0 offen offset:3072 sc1
    s_mov_b32 s76, 200000
L_B_clrP:
    s_waitcnt vmcnt(0)
    v_cmp_gt_u32 vcc, 8, v242
    s_nop 0
    s_cmp_eq_u64 vcc, 0
    s_cbranch_scc1 L_B_clrokP
    buffer_load_dword v242, v243, s[48:51], 0 offen sc1
    s_sub_u32 s76, s76, 1
    s_cmp_eq_u32 s76, 0
    s_cbranch_scc0 L_B_clrP
L_B_clrokP:
    v_mov_b32 v22, 1
    s_mov_b64 exec, 1
    buffer_store_dword v22, v21, s[56:59], 0 offen sc1
    s_endpgm
L_B_uy:
    s_mov_b32 s68, s22
    s_mov_b32 s69, s23
    s_mov_b32 s70, 0x240000
    s_mov_b32 s71, 0x20000
    s_mov_b32 s48, s38
    s_mov_b32 s49, s39
    s_mov_b32 s50, 0x100
    s_mov_b32 s51, 0x20000
    s_and_b32 s3, s45, 7
    s_mul_i32 s3, s3, 1152
    v_subrev_u32 v19, 256, v0
    v_mul_u32_u24 v17, 9216, v19
    v_add_u32 v17, s76, v17
    v_mul_u32_u24 v18, 4608, v19
    v_add_u32 v18, s76, v18
    v_subrev_u32 v14, 2304, v18
    v_add_u32 v15, 1179648, v14
    s_waitcnt lgkmcnt(0)
    buffer_load_dword v13, v17, s[68:71], s3 offen
    s_mov_b32 s77, 1179648
    s_mov_b64 exec, 1
    buffer_load_dwordx4 v[80:83], v14, s[68:71], 0 offen offset:0
    buffer_load_dwordx4 v[84:87], v14, s[68:71], 0 offen offset:1152
    buffer_load_dwordx4 v[104:107], v15, s[68:71], 0 offen offset:0
    buffer_load_dwordx4 v[108:111], v15, s[68:71], 0 offen offset:1152
    s_mov_b64 exec, -1
    buffer_load_dwordx4 v[64:67], v18, s[68:71], 0 offen offset:0
    buffer_load_dwordx4 v[68:71], v18, s[68:71], 0 offen offset:1152
    buffer_load_dwordx4 v[72:75], v18, s[68:71], 0 offen offset:2304
    buffer_load_dwordx4 v[76:79], v18, s[68:71], 0 offen offset:3456
    s_waitcnt vmcnt(2)
    buffer_load_dwordx4 v[88:91], v18, s[68:71], s77 offen offset:0
    buffer_load_dwordx4 v[92:95], v18, s[68:71], s77 offen offset:1152
    buffer_load_dwordx4 v[96:99], v18, s[68:71], s77 offen offset:2304
    buffer_load_dwordx4 v[100:103], v18, s[68:71], s77 offen offset:3456
    buffer_load_dword v242, v243, s[48:51], 0 offen sc1
    s_mov_b32 s76, 0x05040100
    s_mov_b32 s77, 0x07060302
    v_lshlrev_b32 v14, 3, v19
    v_add_u32 v15, 61392, v14
    v_add_u32 v16, 122784, v14
    s_waitcnt vmcnt(5)
    v_perm_b32 v129, v76, v72, s76
    v_perm_b32 v128, v68, v64, s76
    v_perm_b32 v130, v84, v80, s76
    v_mov_b32 v131, v128
    ds_write_b64 v14, v[128:129] offset:5024
    v_mov_b32_dpp v130, v129 wave_shr:1 row_mask:0xf bank_mask:0xf
    ds_write_b64 v14, v[130:131] offset:448
    v_perm_b32 v133, v76, v72, s77
    v_perm_b32 v132, v68, v64, s77
    v_perm_b32 v134, v84, v80, s77
    v_mov_b32 v135, v132
    ds_write_b64 v14, v[132:133] offset:25488
    v_mov_b32_dpp v134, v133 wave_shr:1 row_mask:0xf bank_mask:0xf
    ds_write_b64 v14, v[134:135] offset:20912
    v_perm_b32 v137, v77, v73, s76
    v_perm_b32 v136, v69, v65, s76
    v_perm_b32 v138, v85, v81, s76
    v_mov_b32 v139, v136
    ds_write_b64 v14, v[136:137] offset:45952
    v_mov_b32_dpp v138, v137 wave_shr:1 row_mask:0xf bank_mask:0xf
    ds_write_b64 v14, v[138:139] offset:41376
    v_perm_b32 v141, v77, v73, s77
    v_perm_b32 v140, v69, v65, s77
    v_perm_b32 v142, v85, v81, s77
    v_mov_b32 v143, v140
    ds_write_b64 v15, v[140:141] offset:5024
    v_mov_b32_dpp v142, v141 wave_shr:1 row_mask:0xf bank_mask:0xf
    ds_write_b64 v15, v[142:143] offset:448
    v_perm_b32 v145, v78, v74, s76
    v_perm_b32 v144, v70, v66, s76
    v_perm_b32 v146, v86, v82, s76
    v_mov_b32 v147, v144
    ds_write_b64 v15, v[144:145] offset:25488
    v_mov_b32_dpp v146, v145 wave_shr:1 row_mask:0xf bank_mask:0xf
    ds_write_b64 v15, v[146:147] offset:20912
    v_perm_b32 v149, v78, v74, s77
    v_perm_b32 v148, v70, v66, s77
    v_perm_b32 v150, v86, v82, s77
    v_mov_b32 v151, v148
    ds_write_b64 v15, v[148:149] offset:45952
    v_mov_b32_dpp v150, v149 wave_shr:1 row_mask:0xf bank_mask:0xf
    ds_write_b64 v15, v[150:151] offset:41376
    v_perm_b32 v153, v79, v75, s76
    v_perm_b32 v152, v71, v67, s76
    v_perm_b32 v154, v87, v83, s76
    v_mov_b32 v155, v152
    ds_write_b64 v16, v[152:153] offset:5024
    v_mov_b32_dpp v154, v153 wave_shr:1 row_mask:0xf bank_mask:0xf
    ds_write_b64 v16, v[154:155] offset:448
    v_perm_b32 v157, v79, v75, s77
    v_perm_b32 v156, v71, v67, s77
    v_perm_b32 v158, v87, v83, s77
    v_mov_b32 v159, v156
    ds_write_b64 v16, v[156:157] offset:25488
    v_mov_b32_dpp v158, v157 wave_shr:1 row_mask:0xf bank_mask:0xf
    ds_write_b64 v16, v[158:159] offset:20912
    s_waitcnt lgkmcnt(0)
    s_barrier
    s_setprio 1
    s_waitcnt vmcnt(1)
    v_perm_b32 v161, v100, v96, s76
    v_perm_b32 v160, v92, v88, s76
    v_perm_b32 v162, v108, v104, s76
    v_mov_b32 v163, v160
    ds_write_b64 v14, v[160:161] offset:7072
    v_mov_b32_dpp v162, v161 wave_shr:1 row_mask:0xf bank_mask:0xf
    ds_write_b64 v14, v[162:163] offset:2496
    v_perm_b32 v165, v100, v96, s77
    v_perm_b32 v164, v92, v88, s77
    v_perm_b32 v166, v108, v104, s77
    v_mov_b32 v167, v164
    ds_write_b64 v14, v[164:165] offset:27536
    v_mov_b32_dpp v166, v165 wave_shr:1 row_mask:0xf bank_mask:0xf
    ds_write_b64 v14, v[166:167] offset:22960
    v_perm_b32 v169, v101, v97, s76
    v_perm_b32 v168, v93, v89, s76
    v_perm_b32 v170, v109, v105, s76
    v_mov_b32 v171, v168
    ds_write_b64 v14, v[168:169] offset:48000
    v_mov_b32_dpp v170, v169 wave_shr:1 row_mask:0xf bank_mask:0xf
    ds_write_b64 v14, v[170:171] offset:43424
    v_perm_b32 v173, v101, v97, s77
    v_perm_b32 v172, v93, v89, s77
    v_perm_b32 v174, v109, v105, s77
    v_mov_b32 v175, v172
    ds_write_b64 v15, v[172:173] offset:7072
    v_mov_b32_dpp v174, v173 wave_shr:1 row_mask:0xf bank_mask:0xf
    ds_write_b64 v15, v[174:175] offset:2496
    v_perm_b32 v177, v102, v98, s76
    v_perm_b32 v176, v94, v90, s76
    v_perm_b32 v178, v110, v106, s76
    v_mov_b32 v179, v176
    ds_write_b64 v15, v[176:177] offset:27536
    v_mov_b32_dpp v178, v177 wave_shr:1 row_mask:0xf bank_mask:0xf
    ds_write_b64 v15, v[178:179] offset:22960
    v_perm_b32 v181, v102, v98, s77
    v_perm_b32 v180, v94, v90, s77
    v_perm_b32 v182, v110, v106, s77
    v_mov_b32 v183, v180
    ds_write_b64 v15, v[180:181] offset:48000
    v_mov_b32_dpp v182, v181 wave_shr:1 row_mask:0xf bank_mask:0xf
    ds_write_b64 v15, v[182:183] offset:43424
    v_perm_b32 v185, v103, v99, s76
    v_perm_b32 v184, v95, v91, s76
    v_perm_b32 v186, v111, v107, s76
    v_mov_b32 v187, v184
    ds_write_b64 v16, v[184:185] offset:7072
    v_mov_b32_dpp v186, v185 wave_shr:1 row_mask:0xf bank_mask:0xf
    ds_write_b64 v16, v[186:187] offset:2496
    v_perm_b32 v189, v103, v99, s77
    v_perm_b32 v188, v95, v91, s77
    v_perm_b32 v190, v111, v107, s77
    v_mov_b32 v191, v188
    ds_write_b64 v16, v[188:189] offset:27536
    v_mov_b32_dpp v190, v189 wave_shr:1 row_mask:0xf bank_mask:0xf
    ds_write_b64 v16, v[190:191] offset:22960
    s_waitcnt lgkmcnt(0)
    s_barrier
    s_setprio 1
    v_and_b32 v13, 1, v2
    v_cmp_eq_u32 s[78:79], 1, v13
    v_mul_u32_u24 v14, 81856, v13
    v_lshrrev_b32 v10, 1, v0
    v_lshl_add_u32 v14, v10, 4, v14
    v_add_u32 v14, 5024, v14
    v_lshlrev_b32 v15, 4, v2
    v_sub_u32 v15, 1008, v15
    v_add_u32 v15, s47, v15
    v_bfe_u32 v3, v2, 1, 3
    v_lshrrev_b32 v16, 4, v2
    v_mul_u32_u24 v12, 4224, v13
    v_lshl_add_u32 v12, v16, 4, v12
    v_lshlrev_b32 v17, 3, v3
    v_sub_u32 v12, v12, v17
    v_add_u32 v12, 9176, v12
    v_add_u32 v12, s47, v12
    v_and_b32 v3, 7, v2
    v_bfe_u32 v4, v2, 3, 1
    v_mul_u32_u24 v13, 4576, v4
    v_lshl_add_u32 v13, v16, 4, v13
    v_lshl_add_u32 v13, v3, 6, v13
    v_add_u32 v13, s47, v13
    v_lshrrev_b32 v17, 1, v3
    v_lshl_add_u32 v18, v3, 1, v17
    v_lshlrev_b32 v18, 3, v18
    v_lshl_add_u32 v18, v16, 2, v18
    v_add_u32 v18, v18, v4
    v_lshlrev_b32 v18, 2, v18
    v_add_u32 v18, s47, v18
    s_add_u32 s52, s40, 0x4c0000
    s_addc_u32 s53, s41, 0
    s_mov_b32 s54, 0x120000
    s_mov_b32 s55, 0x20000
    s_add_u32 s56, s40, 0x4a8800
    s_addc_u32 s57, s41, 0
    s_mov_b32 s58, 0x4800
    s_mov_b32 s59, 0x20000
    s_lshl_b32 s76, s85, 12
    v_lshlrev_b32 v20, 4, v2
    v_add_u32 v20, s76, v20
    s_lshl_b32 s76, s85, 6
    v_mov_b32 v21, s76
    s_mov_b32 s76, 200000
L_B_clrY:
    s_waitcnt vmcnt(0)
    v_cmp_gt_u32 vcc, 8, v242
    s_nop 0
    s_cmp_eq_u64 vcc, 0
    s_cbranch_scc1 L_B_clrokY
    buffer_load_dword v242, v243, s[48:51], 0 offen sc1
    s_sub_u32 s76, s76, 1
    s_cmp_eq_u32 s76, 0
    s_cbranch_scc0 L_B_clrY
L_B_clrokY:
    buffer_load_dword v22, v21, s[56:59], 0 offen sc1
    ds_read_b128 v[224:227], v14 offset:0
    ds_read_b128 v[228:231], v14 offset:20464
    ds_read_b128 v[232:235], v14 offset:40928
    ds_read_b128 v[236:239], v14 offset:61392
    v_mov_b32 v16, s88
    v_mov_b32 v17, s90
    v_cndmask_b32 v16, v16, v17, s[78:79]
    v_lshlrev_b32 v24, 16, v16
    v_and_b32 v25, v7, v16
    v_mov_b32 v16, s89
    v_mov_b32 v17, s91
    v_cndmask_b32 v16, v16, v17, s[78:79]
    v_lshlrev_b32 v26, 16, v16
    v_and_b32 v27, v7, v16
    s_waitcnt lgkmcnt(0)
    v_lshlrev_b32 v32, 16, v224
    v_and_b32 v36, v7, v224
    v_mul_f32 v32, v24, v32
    v_mul_f32 v36, v24, v36
    v_cvt_pk_bf16_f32 v36, v32, v36
    v_lshlrev_b32 v32, 16, v36
    v_and_b32 v36, v7, v36
    v_lshlrev_b32 v40, 16, v225
    v_and_b32 v44, v7, v225
    v_mul_f32 v40, v24, v40
    v_mul_f32 v44, v24, v44
    v_cvt_pk_bf16_f32 v44, v40, v44
    v_lshlrev_b32 v40, 16, v44
    v_and_b32 v44, v7, v44
    v_lshlrev_b32 v48, 16, v226
    v_and_b32 v52, v7, v226
    v_mul_f32 v48, v24, v48
    v_mul_f32 v52, v24, v52
    v_cvt_pk_bf16_f32 v52, v48, v52
    v_lshlrev_b32 v48, 16, v52
    v_and_b32 v52, v7, v52
    v_lshlrev_b32 v56, 16, v227
    v_and_b32 v60, v7, v227
    v_mul_f32 v56, v24, v56
    v_mul_f32 v60, v24, v60
    v_cvt_pk_bf16_f32 v60, v56, v60
    v_lshlrev_b32 v56, 16, v60
    v_and_b32 v60, v7, v60
    v_lshlrev_b32 v33, 16, v228
    v_and_b32 v37, v7, v228
    v_mul_f32 v33, v25, v33
    v_mul_f32 v37, v25, v37
    v_cvt_pk_bf16_f32 v37, v33, v37
    v_lshlrev_b32 v33, 16, v37
    v_and_b32 v37, v7, v37
    v_lshlrev_b32 v41, 16, v229
    v_and_b32 v45, v7, v229
    v_mul_f32 v41, v25, v41
    v_mul_f32 v45, v25, v45
    v_cvt_pk_bf16_f32 v45, v41, v45
    v_lshlrev_b32 v41, 16, v45
    v_and_b32 v45, v7, v45
    v_lshlrev_b32 v49, 16, v230
    v_and_b32 v53, v7, v230
    v_mul_f32 v49, v25, v49
    v_mul_f32 v53, v25, v53
    v_cvt_pk_bf16_f32 v53, v49, v53
    v_lshlrev_b32 v49, 16, v53
    v_and_b32 v53, v7, v53
    v_lshlrev_b32 v57, 16, v231
    v_and_b32 v61, v7, v231
    v_mul_f32 v57, v25, v57
    v_mul_f32 v61, v25, v61
    v_cvt_pk_bf16_f32 v61, v57, v61
    v_lshlrev_b32 v57, 16, v61
    v_and_b32 v61, v7, v61
    v_lshlrev_b32 v34, 16, v232
    v_and_b32 v38, v7, v232
    v_mul_f32 v34, v26, v34
    v_mul_f32 v38, v26, v38
    v_cvt_pk_bf16_f32 v38, v34, v38
    v_lshlrev_b32 v34, 16, v38
    v_and_b32 v38, v7, v38
    v_lshlrev_b32 v42, 16, v233
    v_and_b32 v46, v7, v233
    v_mul_f32 v42, v26, v42
    v_mul_f32 v46, v26, v46
    v_cvt_pk_bf16_f32 v46, v42, v46
    v_lshlrev_b32 v42, 16, v46
    v_and_b32 v46, v7, v46
    v_lshlrev_b32 v50, 16, v234
    v_and_b32 v54, v7, v234
    v_mul_f32 v50, v26, v50
    v_mul_f32 v54, v26, v54
    v_cvt_pk_bf16_f32 v54, v50, v54
    v_lshlrev_b32 v50, 16, v54
    v_and_b32 v54, v7, v54
    v_lshlrev_b32 v58, 16, v235
    v_and_b32 v62, v7, v235
    v_mul_f32 v58, v26, v58
    v_mul_f32 v62, v26, v62
    v_cvt_pk_bf16_f32 v62, v58, v62
    v_lshlrev_b32 v58, 16, v62
    v_and_b32 v62, v7, v62
    v_lshlrev_b32 v35, 16, v236
    v_and_b32 v39, v7, v236
    v_mul_f32 v35, v27, v35
    v_mul_f32 v39, v27, v39
    v_cvt_pk_bf16_f32 v39, v35, v39
    v_lshlrev_b32 v35, 16, v39
    v_and_b32 v39, v7, v39
    v_lshlrev_b32 v43, 16, v237
    v_and_b32 v47, v7, v237
    v_mul_f32 v43, v27, v43
    v_mul_f32 v47, v27, v47
    v_cvt_pk_bf16_f32 v47, v43, v47
    v_lshlrev_b32 v43, 16, v47
    v_and_b32 v47, v7, v47
    v_lshlrev_b32 v51, 16, v238
    v_and_b32 v55, v7, v238
    v_mul_f32 v51, v27, v51
    v_mul_f32 v55, v27, v55
    v_cvt_pk_bf16_f32 v55, v51, v55
    v_lshlrev_b32 v51, 16, v55
    v_and_b32 v55, v7, v55
    v_lshlrev_b32 v59, 16, v239
    v_and_b32 v63, v7, v239
    v_mul_f32 v59, v27, v59
    v_mul_f32 v63, v27, v63
    v_cvt_pk_bf16_f32 v63, v59, v63
    v_lshlrev_b32 v59, 16, v63
    v_and_b32 v63, v7, v63
    v_lshrrev_b32 v10, 1, v0
    v_and_b32 v9, 127, v10
    v_lshrrev_b32 v8, 3, v9
    v_lshlrev_b32 v8, 5, v8
    v_lshl_add_u32 v8, v9, 4, v8
    v_and_b32 v9, 1, v0
    v_mul_u32_u24 v11, 81856, v9
    v_add_u32 v8, v8, v11
    s_cmp_lt_u32 s44, 4
    s_cselect_b32 s76, 8384, 0
    s_add_u32 s76, s76, 9120
    v_add_u32 v8, s76, v8
    v_mul_u32_u24 v11, 36864, v10
    v_lshl_add_u32 v11, v9, 4, v11
    s_lshl_b32 s76, s45, 5
    s_add_u32 s76, s76, 2304
    v_add_u32 v11, s76, v11
    s_mov_b32 s76, 200000
    s_branch L_B_kchk
L_B_kpoll:
    buffer_load_dword v22, v21, s[56:59], 0 offen sc1
L_B_kchk:
    s_waitcnt vmcnt(0)
    v_cmp_ne_u32 vcc, 1, v22
    s_nop 0
    s_cmp_eq_u64 vcc, 0
    s_cbranch_scc1 L_B_kok
    s_sleep 4
    s_sub_u32 s76, s76, 1
    s_cmp_eq_u32 s76, 0
    s_cbranch_scc0 L_B_kpoll
L_B_kok:
    buffer_load_dwordx4 v[192:195], v20, s[52:55], 0 offen offset:0 sc1
    buffer_load_dwordx4 v[196:199], v20, s[52:55], 0 offen offset:1024 sc1
    buffer_load_dwordx4 v[200:203], v20, s[52:55], 0 offen offset:2048 sc1
    buffer_load_dwordx4 v[204:207], v20, s[52:55], 0 offen offset:3072 sc1
    s_waitcnt vmcnt(0)
L_B_expand:
    s_nop 7
    s_nop 3
    s_mov_b32 exec_lo, 0xff
    s_mov_b32 exec_hi, 0
    ds_write_b64 v5, v[240:241] offset:13216
    ds_write_b64 v5, v[240:241] offset:17440
    s_mov_b64 exec, -1
    v_mov_b32_dpp v20, v200 wave_rol:1 row_mask:0xf bank_mask:0xf
    v_mov_b32_dpp v21, v202 wave_rol:1 row_mask:0xf bank_mask:0xf
    v_mov_b32_dpp v22, v203 wave_rol:1 row_mask:0xf bank_mask:0xf
    v_mov_b32_dpp v23, v204 wave_rol:1 row_mask:0xf bank_mask:0xf
    v_mov_b32_dpp v20, v192 wave_shl:1 row_mask:0xf bank_mask:0xf
    v_mov_b32_dpp v21, v200 wave_shl:1 row_mask:0xf bank_mask:0xf
    v_mov_b32_dpp v22, v202 wave_shl:1 row_mask:0xf bank_mask:0xf
    v_mov_b32_dpp v23, v203 wave_shl:1 row_mask:0xf bank_mask:0xf
    s_mov_b32 exec_lo, 0
    v_mov_b32 v199, v20
    s_mov_b32 exec_lo, -1
    v_cndmask_b32 v25, v202, v22, s[78:79]
    v_cndmask_b32 v26, v203, v23, s[78:79]
    v_mov_b32_dpp v24, v199 wave_shr:1 row_mask:0xf bank_mask:0xf bound_ctrl:0
    v_cvt_pk_bf16_f32 v64, v21, v21
    v_cvt_pk_bf16_f32 v65, v201, v201
    v_cvt_pk_bf16_f32 v66, v201, v200
    v_cvt_pk_bf16_f32 v67, v200, v200
    ds_write_b128 v15, v[64:67] offset:15392
    v_cvt_pk_bf16_f32 v68, v21, v201
    v_cvt_pk_bf16_f32 v69, v201, v201
    v_cvt_pk_bf16_f32 v70, v200, v200
    v_cvt_pk_bf16_f32 v71, v200, v200
    ds_write_b128 v15, v[68:71] offset:11168
    v_cvt_pk_bf16_f32 v72, v22, v22
    v_cvt_pk_bf16_f32 v73, v22, v25
    v_cvt_pk_bf16_f32 v74, v202, v202
    v_cvt_pk_bf16_f32 v75, v202, v202
    ds_write_b128 v15, v[72:75] offset:14368
    v_cvt_pk_bf16_f32 v76, v22, v22
    v_cvt_pk_bf16_f32 v77, v25, v202
    v_cvt_pk_bf16_f32 v78, v202, v202
    v_cvt_pk_bf16_f32 v79, v202, v202
    ds_write_b128 v15, v[76:79] offset:10144
    v_cvt_pk_bf16_f32 v64, v23, v23
    v_cvt_pk_bf16_f32 v65, v23, v26
    v_cvt_pk_bf16_f32 v66, v203, v203
    v_cvt_pk_bf16_f32 v67, v203, v203
    ds_write_b128 v15, v[64:67] offset:13344
    v_cvt_pk_bf16_f32 v68, v23, v23
    v_cvt_pk_bf16_f32 v69, v26, v203
    v_cvt_pk_bf16_f32 v70, v203, v203
    v_cvt_pk_bf16_f32 v71, v203, v203
    ds_write_b128 v15, v[68:71] offset:9120
    v_cvt_pk_bf16_f32 v72, v199, v198
    v_cvt_pk_bf16_f32 v73, v197, v196
    v_cvt_pk_bf16_f32 v74, v195, v194
    v_cvt_pk_bf16_f32 v75, v193, v192
    ds_write_b128 v15, v[72:75] offset:16416
    v_cvt_pk_bf16_f32 v76, v198, v197
    v_cvt_pk_bf16_f32 v77, v196, v195
    v_cvt_pk_bf16_f32 v78, v194, v193
    v_cvt_pk_bf16_f32 v79, v192, v24
    ds_write_b128 v15, v[76:79] offset:12192
    s_setprio 0
    s_cmp_lt_u32 s44, 4
    s_cbranch_scc0 L_B_nobU
    s_waitcnt vmcnt(0)
    s_barrier
L_B_nobU:
    v_add_u32 v30, 2048, v12
    v_add_u32 v31, 2048, v12
    ds_read_b64 v[64:65], v12 offset:3584
    ds_read_b64 v[66:67], v12 offset:3592
    ds_read_b128 v[128:131], v13 offset:0
    ds_read_b128 v[132:135], v13 offset:512
    ds_read_b128 v[136:139], v13 offset:1024
    ds_read_b128 v[140:143], v13 offset:1536
    ds_read_b64 v[68:69], v12 offset:3072
    ds_read_b64 v[70:71], v12 offset:3080
    ds_read_b64 v[72:73], v12 offset:2560
    ds_read_b64 v[74:75], v12 offset:2568
    ds_read_b64 v[76:77], v12 offset:2048
    ds_read_b64 v[78:79], v12 offset:2056
    ds_read_b64 v[80:81], v12 offset:1536
    ds_read_b64 v[82:83], v12 offset:1544
    ds_read_b64 v[84:85], v12 offset:1024
    ds_read_b64 v[86:87], v12 offset:1032
    ds_read_b64 v[88:89], v12 offset:512
    ds_read_b64 v[90:91], v12 offset:520
    ds_read_b64 v[92:93], v12 offset:0
    ds_read_b64 v[94:95], v12 offset:8
    v_mov_b32 v192, 0
    v_mov_b32 v193, 0
    v_mov_b32 v194, 0
    v_mov_b32 v195, 0
    v_mov_b32 v196, 0
    v_mov_b32 v197, 0
    v_mov_b32 v198, 0
    v_mov_b32 v199, 0
    v_mov_b32 v200, 0
    v_mov_b32 v201, 0
    v_mov_b32 v202, 0
    v_mov_b32 v203, 0
    v_mov_b32 v204, 0
    v_mov_b32 v205, 0
    v_mov_b32 v206, 0
    v_mov_b32 v207, 0
    v_mov_b32 v208, 0
    v_mov_b32 v209, 0
    v_mov_b32 v210, 0
    v_mov_b32 v211, 0
    v_mov_b32 v212, 0
    v_mov_b32 v213, 0
    v_mov_b32 v214, 0
    v_mov_b32 v215, 0
    v_mov_b32 v216, 0
    v_mov_b32 v217, 0
    v_mov_b32 v218, 0
    v_mov_b32 v219, 0
    v_mov_b32 v220, 0
    v_mov_b32 v221, 0
    v_mov_b32 v222, 0
    v_mov_b32 v223, 0
    v_mov_b32 v28, v12
    v_mov_b32 v29, v13
    s_mov_b32 s76, 0
L_B_loopX:
    s_waitcnt lgkmcnt(11)
    v_mfma_f32_16x16x32_bf16 v[192:195], v[64:67], v[128:131], v[192:195]
    ds_read_b64 v[96:97], v12 offset:3648
    v_mfma_f32_16x16x32_bf16 v[196:199], v[64:67], v[132:135], v[196:199]
    ds_read_b64 v[98:99], v12 offset:3656
    v_mfma_f32_16x16x32_bf16 v[200:203], v[64:67], v[136:139], v[200:203]
    ds_read_b128 v[160:163], v13 offset:64
    v_mfma_f32_16x16x32_bf16 v[204:207], v[64:67], v[140:143], v[204:207]
    ds_read_b128 v[164:167], v13 offset:576
    v_mfma_f32_16x16x32_bf16 v[196:199], v[68:71], v[128:131], v[196:199]
    v_mfma_f32_16x16x32_bf16 v[200:203], v[68:71], v[132:135], v[200:203]
    ds_read_b128 v[168:171], v13 offset:1088
    v_mfma_f32_16x16x32_bf16 v[204:207], v[68:71], v[136:139], v[204:207]
    ds_read_b128 v[172:175], v13 offset:1600
    v_mfma_f32_16x16x32_bf16 v[208:211], v[68:71], v[140:143], v[208:211]
    ds_read_b64 v[100:101], v12 offset:3136
    s_waitcnt lgkmcnt(11)
    v_mfma_f32_16x16x32_bf16 v[200:203], v[72:75], v[128:131], v[200:203]
    v_mfma_f32_16x16x32_bf16 v[204:207], v[72:75], v[132:135], v[204:207]
    ds_read_b64 v[102:103], v12 offset:3144
    v_mfma_f32_16x16x32_bf16 v[208:211], v[72:75], v[136:139], v[208:211]
    ds_read_b64 v[104:105], v12 offset:2624
    v_mfma_f32_16x16x32_bf16 v[212:215], v[72:75], v[140:143], v[212:215]
    ds_read_b64 v[106:107], v12 offset:2632
    v_mfma_f32_16x16x32_bf16 v[204:207], v[76:79], v[128:131], v[204:207]
    v_mfma_f32_16x16x32_bf16 v[208:211], v[76:79], v[132:135], v[208:211]
    ds_read_b64 v[108:109], v12 offset:2112
    v_mfma_f32_16x16x32_bf16 v[212:215], v[76:79], v[136:139], v[212:215]
    ds_read_b64 v[110:111], v12 offset:2120
    v_mfma_f32_16x16x32_bf16 v[216:219], v[76:79], v[140:143], v[216:219]
    ds_read_b64 v[112:113], v12 offset:1600
    v_mfma_f32_16x16x32_bf16 v[208:211], v[80:83], v[128:131], v[208:211]
    ds_read_b64 v[114:115], v12 offset:1608
    v_mfma_f32_16x16x32_bf16 v[212:215], v[80:83], v[132:135], v[212:215]
    v_mfma_f32_16x16x32_bf16 v[216:219], v[80:83], v[136:139], v[216:219]
    ds_read_b64 v[116:117], v12 offset:1088
    v_mfma_f32_16x16x32_bf16 v[220:223], v[80:83], v[140:143], v[220:223]
    ds_read_b64 v[118:119], v12 offset:1096
    v_mfma_f32_16x16x32_bf16 v[212:215], v[84:87], v[128:131], v[212:215]
    ds_read_b64 v[120:121], v12 offset:576
    v_mfma_f32_16x16x32_bf16 v[216:219], v[84:87], v[132:135], v[216:219]
    v_mfma_f32_16x16x32_bf16 v[220:223], v[84:87], v[136:139], v[220:223]
    ds_read_b64 v[122:123], v12 offset:584
    s_waitcnt lgkmcnt(11)
    v_mfma_f32_16x16x32_bf16 v[216:219], v[88:91], v[128:131], v[216:219]
    ds_read_b64 v[124:125], v12 offset:64
    v_mfma_f32_16x16x32_bf16 v[220:223], v[88:91], v[132:135], v[220:223]
    ds_read_b64 v[126:127], v12 offset:72
    v_mfma_f32_16x16x32_bf16 v[220:223], v[92:95], v[128:131], v[220:223]
    s_waitcnt lgkmcnt(11)
    v_mfma_f32_16x16x32_bf16 v[192:195], v[96:99], v[160:163], v[192:195]
    ds_read_b64 v[64:65], v12 offset:3712
    v_mfma_f32_16x16x32_bf16 v[196:199], v[96:99], v[164:167], v[196:199]
    ds_read_b64 v[66:67], v12 offset:3720
    v_mfma_f32_16x16x32_bf16 v[200:203], v[96:99], v[168:171], v[200:203]
    ds_read_b128 v[128:131], v13 offset:128
    v_mfma_f32_16x16x32_bf16 v[204:207], v[96:99], v[172:175], v[204:207]
    ds_read_b128 v[132:135], v13 offset:640
    v_mfma_f32_16x16x32_bf16 v[196:199], v[100:103], v[160:163], v[196:199]
    ds_read_b128 v[136:139], v13 offset:1152
    v_mfma_f32_16x16x32_bf16 v[200:203], v[100:103], v[164:167], v[200:203]
    ds_read_b128 v[140:143], v13 offset:1664
    v_mfma_f32_16x16x32_bf16 v[204:207], v[100:103], v[168:171], v[204:207]
    ds_read_b64 v[68:69], v12 offset:3200
    v_mfma_f32_16x16x32_bf16 v[208:211], v[100:103], v[172:175], v[208:211]
    s_waitcnt lgkmcnt(11)
    v_mfma_f32_16x16x32_bf16 v[200:203], v[104:107], v[160:163], v[200:203]
    ds_read_b64 v[70:71], v12 offset:3208
    v_mfma_f32_16x16x32_bf16 v[204:207], v[104:107], v[164:167], v[204:207]
    ds_read_b64 v[72:73], v12 offset:2688
    v_mfma_f32_16x16x32_bf16 v[208:211], v[104:107], v[168:171], v[208:211]
    ds_read_b64 v[74:75], v12 offset:2696
    v_mfma_f32_16x16x32_bf16 v[212:215], v[104:107], v[172:175], v[212:215]
    ds_read_b64 v[76:77], v12 offset:2176
    v_mfma_f32_16x16x32_bf16 v[204:207], v[108:111], v[160:163], v[204:207]
    ds_read_b64 v[78:79], v12 offset:2184
    v_mfma_f32_16x16x32_bf16 v[208:211], v[108:111], v[164:167], v[208:211]
    ds_read_b64 v[80:81], v12 offset:1664
    v_mfma_f32_16x16x32_bf16 v[212:215], v[108:111], v[168:171], v[212:215]
    ds_read_b64 v[82:83], v12 offset:1672
    v_mfma_f32_16x16x32_bf16 v[216:219], v[108:111], v[172:175], v[216:219]
    v_mfma_f32_16x16x32_bf16 v[208:211], v[112:115], v[160:163], v[208:211]
    ds_read_b64 v[84:85], v12 offset:1152
    v_mfma_f32_16x16x32_bf16 v[212:215], v[112:115], v[164:167], v[212:215]
    ds_read_b64 v[86:87], v12 offset:1160
    v_mfma_f32_16x16x32_bf16 v[216:219], v[112:115], v[168:171], v[216:219]
    ds_read_b64 v[88:89], v12 offset:640
    v_mfma_f32_16x16x32_bf16 v[220:223], v[112:115], v[172:175], v[220:223]
    ds_read_b64 v[90:91], v12 offset:648
    v_mfma_f32_16x16x32_bf16 v[212:215], v[116:119], v[160:163], v[212:215]
    ds_read_b64 v[92:93], v12 offset:128
    v_mfma_f32_16x16x32_bf16 v[216:219], v[116:119], v[164:167], v[216:219]
    ds_read_b64 v[94:95], v12 offset:136
    v_mfma_f32_16x16x32_bf16 v[220:223], v[116:119], v[168:171], v[220:223]
    s_waitcnt lgkmcnt(11)
    v_mfma_f32_16x16x32_bf16 v[216:219], v[120:123], v[160:163], v[216:219]
    v_add_u32 v12, 128, v12
    v_add_u32 v13, 128, v13
    v_mfma_f32_16x16x32_bf16 v[220:223], v[120:123], v[164:167], v[220:223]
    v_add_u32 v30, 128, v30
    s_add_u32 s76, s76, 1
    s_cmp_lt_u32 s76, 3
    v_mfma_f32_16x16x32_bf16 v[220:223], v[124:127], v[160:163], v[220:223]
    s_cbranch_scc1 L_B_loopX
    s_cmp_lt_u32 s44, 4
    s_cbranch_scc0 L_B_noU2
    s_barrier
L_B_noU2:
    s_waitcnt lgkmcnt(11)
    v_mfma_f32_16x16x32_bf16 v[192:195], v[64:67], v[128:131], v[192:195]
    ds_read_b64 v[96:97], v12 offset:3648
    v_mfma_f32_16x16x32_bf16 v[196:199], v[64:67], v[132:135], v[196:199]
    ds_read_b64 v[98:99], v12 offset:3656
    v_mfma_f32_16x16x32_bf16 v[200:203], v[64:67], v[136:139], v[200:203]
    ds_read_b128 v[160:163], v13 offset:64
    v_mfma_f32_16x16x32_bf16 v[204:207], v[64:67], v[140:143], v[204:207]
    ds_read_b128 v[164:167], v13 offset:576
    v_mfma_f32_16x16x32_bf16 v[196:199], v[68:71], v[128:131], v[196:199]
    v_mfma_f32_16x16x32_bf16 v[200:203], v[68:71], v[132:135], v[200:203]
    ds_read_b128 v[168:171], v13 offset:1088
    v_mfma_f32_16x16x32_bf16 v[204:207], v[68:71], v[136:139], v[204:207]
    ds_read_b128 v[172:175], v13 offset:1600
    v_mfma_f32_16x16x32_bf16 v[208:211], v[68:71], v[140:143], v[208:211]
    ds_read_b64 v[100:101], v12 offset:3136
    s_waitcnt lgkmcnt(11)
    v_mfma_f32_16x16x32_bf16 v[200:203], v[72:75], v[128:131], v[200:203]
    v_mfma_f32_16x16x32_bf16 v[204:207], v[72:75], v[132:135], v[204:207]
    ds_read_b64 v[102:103], v12 offset:3144
    v_mfma_f32_16x16x32_bf16 v[208:211], v[72:75], v[136:139], v[208:211]
    ds_read_b64 v[104:105], v12 offset:2624
    v_mfma_f32_16x16x32_bf16 v[212:215], v[72:75], v[140:143], v[212:215]
    ds_read_b64 v[106:107], v12 offset:2632
    v_mfma_f32_16x16x32_bf16 v[204:207], v[76:79], v[128:131], v[204:207]
    v_mfma_f32_16x16x32_bf16 v[208:211], v[76:79], v[132:135], v[208:211]
    ds_read_b64 v[108:109], v12 offset:2112
    v_mfma_f32_16x16x32_bf16 v[212:215], v[76:79], v[136:139], v[212:215]
    ds_read_b64 v[110:111], v12 offset:2120
    v_mfma_f32_16x16x32_bf16 v[216:219], v[76:79], v[140:143], v[216:219]
    ds_read_b64 v[112:113], v12 offset:1600
    v_mfma_f32_16x16x32_bf16 v[208:211], v[80:83], v[128:131], v[208:211]
    ds_read_b64 v[114:115], v12 offset:1608
    v_mfma_f32_16x16x32_bf16 v[212:215], v[80:83], v[132:135], v[212:215]
    v_mfma_f32_16x16x32_bf16 v[216:219], v[80:83], v[136:139], v[216:219]
    ds_read_b64 v[116:117], v12 offset:1088
    v_mfma_f32_16x16x32_bf16 v[220:223], v[80:83], v[140:143], v[220:223]
    ds_read_b64 v[118:119], v12 offset:1096
    v_mfma_f32_16x16x32_bf16 v[212:215], v[84:87], v[128:131], v[212:215]
    ds_read_b64 v[120:121], v12 offset:576
    v_mfma_f32_16x16x32_bf16 v[216:219], v[84:87], v[132:135], v[216:219]
    v_mfma_f32_16x16x32_bf16 v[220:223], v[84:87], v[136:139], v[220:223]
    ds_read_b64 v[122:123], v12 offset:584
    s_waitcnt lgkmcnt(11)
    v_mfma_f32_16x16x32_bf16 v[216:219], v[88:91], v[128:131], v[216:219]
    ds_read_b64 v[124:125], v12 offset:64
    v_mfma_f32_16x16x32_bf16 v[220:223], v[88:91], v[132:135], v[220:223]
    ds_read_b64 v[126:127], v12 offset:72
    v_mfma_f32_16x16x32_bf16 v[220:223], v[92:95], v[128:131], v[220:223]
    s_waitcnt lgkmcnt(11)
    v_mfma_f32_16x16x32_bf16 v[192:195], v[96:99], v[160:163], v[192:195]
    ds_read_b64 v[64:65], v28 offset:3584
    v_mfma_f32_16x16x32_bf16 v[196:199], v[96:99], v[164:167], v[196:199]
    ds_read_b64 v[66:67], v28 offset:3592
    v_mfma_f32_16x16x32_bf16 v[200:203], v[96:99], v[168:171], v[200:203]
    ds_read_b128 v[128:131], v29 offset:2048
    v_mfma_f32_16x16x32_bf16 v[204:207], v[96:99], v[172:175], v[204:207]
    ds_read_b128 v[132:135], v29 offset:2560
    v_mfma_f32_16x16x32_bf16 v[196:199], v[100:103], v[160:163], v[196:199]
    ds_read_b128 v[136:139], v29 offset:3072
    v_mfma_f32_16x16x32_bf16 v[200:203], v[100:103], v[164:167], v[200:203]
    ds_read_b128 v[140:143], v29 offset:3584
    v_mfma_f32_16x16x32_bf16 v[204:207], v[100:103], v[168:171], v[204:207]
    ds_read_b64 v[68:69], v28 offset:3072
    v_mfma_f32_16x16x32_bf16 v[208:211], v[100:103], v[172:175], v[208:211]
    ds_read_b64 v[70:71], v28 offset:3080
    s_waitcnt lgkmcnt(11)
    v_mfma_f32_16x16x32_bf16 v[200:203], v[104:107], v[160:163], v[200:203]
    ds_read_b64 v[72:73], v28 offset:2560
    v_mfma_f32_16x16x32_bf16 v[204:207], v[104:107], v[164:167], v[204:207]
    ds_read_b64 v[74:75], v28 offset:2568
    v_mfma_f32_16x16x32_bf16 v[208:211], v[104:107], v[168:171], v[208:211]
    ds_read_b64 v[76:77], v28 offset:2048
    v_mfma_f32_16x16x32_bf16 v[212:215], v[104:107], v[172:175], v[212:215]
    ds_read_b64 v[78:79], v28 offset:2056
    v_mfma_f32_16x16x32_bf16 v[204:207], v[108:111], v[160:163], v[204:207]
    v_mfma_f32_16x16x32_bf16 v[208:211], v[108:111], v[164:167], v[208:211]
    ds_read_b64 v[80:81], v28 offset:3648
    v_mfma_f32_16x16x32_bf16 v[212:215], v[108:111], v[168:171], v[212:215]
    ds_read_b64 v[82:83], v28 offset:3656
    v_mfma_f32_16x16x32_bf16 v[216:219], v[108:111], v[172:175], v[216:219]
    ds_read_b128 v[144:147], v29 offset:2112
    v_mfma_f32_16x16x32_bf16 v[208:211], v[112:115], v[160:163], v[208:211]
    ds_read_b128 v[148:151], v29 offset:2624
    v_mfma_f32_16x16x32_bf16 v[212:215], v[112:115], v[164:167], v[212:215]
    ds_read_b128 v[152:155], v29 offset:3136
    v_mfma_f32_16x16x32_bf16 v[216:219], v[112:115], v[168:171], v[216:219]
    ds_read_b128 v[156:159], v29 offset:3648
    v_mfma_f32_16x16x32_bf16 v[220:223], v[112:115], v[172:175], v[220:223]
    ds_read_b64 v[84:85], v28 offset:3136
    v_mfma_f32_16x16x32_bf16 v[212:215], v[116:119], v[160:163], v[212:215]
    ds_read_b64 v[86:87], v28 offset:3144
    v_mfma_f32_16x16x32_bf16 v[216:219], v[116:119], v[164:167], v[216:219]
    ds_read_b64 v[88:89], v28 offset:2624
    v_mfma_f32_16x16x32_bf16 v[220:223], v[116:119], v[168:171], v[220:223]
    ds_read_b64 v[90:91], v28 offset:2632
    s_waitcnt lgkmcnt(11)
    v_mfma_f32_16x16x32_bf16 v[216:219], v[120:123], v[160:163], v[216:219]
    ds_read_b64 v[92:93], v28 offset:2112
    v_mfma_f32_16x16x32_bf16 v[220:223], v[120:123], v[164:167], v[220:223]
    ds_read_b64 v[94:95], v28 offset:2120
    v_mfma_f32_16x16x32_bf16 v[220:223], v[124:127], v[160:163], v[220:223]
    s_waitcnt lgkmcnt(11)
    v_mfma_f32_16x16x32_bf16 v[208:211], v[64:67], v[128:131], v[208:211]
    ds_read_b64 v[96:97], v28 offset:3712
    ds_read_b64 v[98:99], v28 offset:3720
    v_mfma_f32_16x16x32_bf16 v[212:215], v[64:67], v[132:135], v[212:215]
    ds_read_b128 v[160:163], v29 offset:2176
    v_mfma_f32_16x16x32_bf16 v[216:219], v[64:67], v[136:139], v[216:219]
    ds_read_b128 v[164:167], v29 offset:2688
    v_mfma_f32_16x16x32_bf16 v[220:223], v[64:67], v[140:143], v[220:223]
    ds_read_b128 v[168:171], v29 offset:3200
    v_mfma_f32_16x16x32_bf16 v[212:215], v[68:71], v[128:131], v[212:215]
    ds_read_b128 v[172:175], v29 offset:3712
    v_mfma_f32_16x16x32_bf16 v[216:219], v[68:71], v[132:135], v[216:219]
    ds_read_b64 v[100:101], v28 offset:3200
    ds_read_b64 v[102:103], v28 offset:3208
    v_mfma_f32_16x16x32_bf16 v[220:223], v[68:71], v[136:139], v[220:223]
    ds_read_b64 v[104:105], v28 offset:2688
    v_mfma_f32_16x16x32_bf16 v[216:219], v[72:75], v[128:131], v[216:219]
    ds_read_b64 v[106:107], v28 offset:2696
    v_mfma_f32_16x16x32_bf16 v[220:223], v[72:75], v[132:135], v[220:223]
    ds_read_b64 v[108:109], v28 offset:2176
    v_mfma_f32_16x16x32_bf16 v[220:223], v[76:79], v[128:131], v[220:223]
    ds_read_b64 v[110:111], v28 offset:2184
    s_waitcnt lgkmcnt(11)
    v_mfma_f32_16x16x32_bf16 v[208:211], v[80:83], v[144:147], v[208:211]
    ds_read_b64 v[112:113], v28 offset:3776
    ds_read_b64 v[114:115], v28 offset:3784
    v_mfma_f32_16x16x32_bf16 v[212:215], v[80:83], v[148:151], v[212:215]
    ds_read_b128 v[176:179], v29 offset:2240
    v_mfma_f32_16x16x32_bf16 v[216:219], v[80:83], v[152:155], v[216:219]
    ds_read_b128 v[180:183], v29 offset:2752
    v_mfma_f32_16x16x32_bf16 v[220:223], v[80:83], v[156:159], v[220:223]
    ds_read_b128 v[184:187], v29 offset:3264
    v_mfma_f32_16x16x32_bf16 v[212:215], v[84:87], v[144:147], v[212:215]
    ds_read_b128 v[188:191], v29 offset:3776
    v_mfma_f32_16x16x32_bf16 v[216:219], v[84:87], v[148:151], v[216:219]
    ds_read_b64 v[116:117], v28 offset:3264
    ds_read_b64 v[118:119], v28 offset:3272
    v_mfma_f32_16x16x32_bf16 v[220:223], v[84:87], v[152:155], v[220:223]
    ds_read_b64 v[120:121], v28 offset:2752
    v_mfma_f32_16x16x32_bf16 v[216:219], v[88:91], v[144:147], v[216:219]
    ds_read_b64 v[122:123], v28 offset:2760
    v_mfma_f32_16x16x32_bf16 v[220:223], v[88:91], v[148:151], v[220:223]
    ds_read_b64 v[124:125], v28 offset:2240
    v_mfma_f32_16x16x32_bf16 v[220:223], v[92:95], v[144:147], v[220:223]
    ds_read_b64 v[126:127], v28 offset:2248
    v_cvt_pk_bf16_f32 v20, v192, v193
    v_cvt_pk_bf16_f32 v21, v194, v195
    ds_write_b32 v18, v20 offset:17504
    ds_write_b32 v18, v21 offset:17512
    v_cvt_pk_bf16_f32 v22, v196, v197
    v_cvt_pk_bf16_f32 v23, v198, v199
    ds_write_b32 v18, v22 offset:18144
    ds_write_b32 v18, v23 offset:18152
    v_cvt_pk_bf16_f32 v20, v200, v201
    v_cvt_pk_bf16_f32 v21, v202, v203
    ds_write_b32 v18, v20 offset:18784
    ds_write_b32 v18, v21 offset:18792
    v_cvt_pk_bf16_f32 v22, v204, v205
    v_cvt_pk_bf16_f32 v23, v206, v207
    ds_write_b32 v18, v22 offset:19424
    ds_write_b32 v18, v23 offset:19432
    s_cmp_lt_u32 s44, 4
    s_cbranch_scc1 L_B_nob3
    s_waitcnt lgkmcnt(0)
    s_barrier
L_B_nob3:
    s_waitcnt lgkmcnt(11)
    v_mfma_f32_16x16x32_bf16 v[208:211], v[96:99], v[160:163], v[208:211]
    ds_read_b64 v[64:65], v28 offset:3840
    ds_read_b64 v[66:67], v28 offset:3848
    v_mfma_f32_16x16x32_bf16 v[212:215], v[96:99], v[164:167], v[212:215]
    ds_read_b128 v[128:131], v29 offset:2304
    v_mfma_f32_16x16x32_bf16 v[216:219], v[96:99], v[168:171], v[216:219]
    ds_read_b128 v[132:135], v29 offset:2816
    v_mfma_f32_16x16x32_bf16 v[220:223], v[96:99], v[172:175], v[220:223]
    ds_read_b128 v[136:139], v29 offset:3328
    v_mfma_f32_16x16x32_bf16 v[212:215], v[100:103], v[160:163], v[212:215]
    ds_read_b128 v[140:143], v29 offset:3840
    v_mfma_f32_16x16x32_bf16 v[216:219], v[100:103], v[164:167], v[216:219]
    ds_read_b64 v[68:69], v28 offset:3328
    ds_read_b64 v[70:71], v28 offset:3336
    v_mfma_f32_16x16x32_bf16 v[220:223], v[100:103], v[168:171], v[220:223]
    ds_read_b64 v[72:73], v28 offset:2816
    v_mfma_f32_16x16x32_bf16 v[216:219], v[104:107], v[160:163], v[216:219]
    ds_read_b64 v[74:75], v28 offset:2824
    v_mfma_f32_16x16x32_bf16 v[220:223], v[104:107], v[164:167], v[220:223]
    ds_read_b64 v[76:77], v28 offset:2304
    v_mfma_f32_16x16x32_bf16 v[220:223], v[108:111], v[160:163], v[220:223]
    ds_read_b64 v[78:79], v28 offset:2312
    s_waitcnt lgkmcnt(11)
    v_mfma_f32_16x16x32_bf16 v[208:211], v[112:115], v[176:179], v[208:211]
    ds_read_b64 v[80:81], v28 offset:3904
    ds_read_b64 v[82:83], v28 offset:3912
    v_mfma_f32_16x16x32_bf16 v[212:215], v[112:115], v[180:183], v[212:215]
    ds_read_b128 v[144:147], v29 offset:2368
    v_mfma_f32_16x16x32_bf16 v[216:219], v[112:115], v[184:187], v[216:219]
    ds_read_b128 v[148:151], v29 offset:2880
    v_mfma_f32_16x16x32_bf16 v[220:223], v[112:115], v[188:191], v[220:223]
    ds_read_b128 v[152:155], v29 offset:3392
    v_mfma_f32_16x16x32_bf16 v[212:215], v[116:119], v[176:179], v[212:215]
    ds_read_b128 v[156:159], v29 offset:3904
    v_mfma_f32_16x16x32_bf16 v[216:219], v[116:119], v[180:183], v[216:219]
    ds_read_b64 v[84:85], v28 offset:3392
    ds_read_b64 v[86:87], v28 offset:3400
    v_mfma_f32_16x16x32_bf16 v[220:223], v[116:119], v[184:187], v[220:223]
    ds_read_b64 v[88:89], v28 offset:2880
    v_mfma_f32_16x16x32_bf16 v[216:219], v[120:123], v[176:179], v[216:219]
    ds_read_b64 v[90:91], v28 offset:2888
    v_mfma_f32_16x16x32_bf16 v[220:223], v[120:123], v[180:183], v[220:223]
    ds_read_b64 v[92:93], v28 offset:2368
    v_mfma_f32_16x16x32_bf16 v[220:223], v[124:127], v[176:179], v[220:223]
    ds_read_b64 v[94:95], v28 offset:2376
    s_waitcnt lgkmcnt(11)
    v_mfma_f32_16x16x32_bf16 v[208:211], v[64:67], v[128:131], v[208:211]
    ds_read_b64 v[96:97], v28 offset:3968
    ds_read_b64 v[98:99], v28 offset:3976
    v_mfma_f32_16x16x32_bf16 v[212:215], v[64:67], v[132:135], v[212:215]
    ds_read_b128 v[160:163], v29 offset:2432
    v_mfma_f32_16x16x32_bf16 v[216:219], v[64:67], v[136:139], v[216:219]
    ds_read_b128 v[164:167], v29 offset:2944
    v_mfma_f32_16x16x32_bf16 v[220:223], v[64:67], v[140:143], v[220:223]
    ds_read_b128 v[168:171], v29 offset:3456
    v_mfma_f32_16x16x32_bf16 v[212:215], v[68:71], v[128:131], v[212:215]
    ds_read_b128 v[172:175], v29 offset:3968
    v_mfma_f32_16x16x32_bf16 v[216:219], v[68:71], v[132:135], v[216:219]
    ds_read_b64 v[100:101], v28 offset:3456
    ds_read_b64 v[102:103], v28 offset:3464
    v_mfma_f32_16x16x32_bf16 v[220:223], v[68:71], v[136:139], v[220:223]
    ds_read_b64 v[104:105], v28 offset:2944
    v_mfma_f32_16x16x32_bf16 v[216:219], v[72:75], v[128:131], v[216:219]
    ds_read_b64 v[106:107], v28 offset:2952
    v_mfma_f32_16x16x32_bf16 v[220:223], v[72:75], v[132:135], v[220:223]
    ds_read_b64 v[108:109], v28 offset:2432
    v_mfma_f32_16x16x32_bf16 v[220:223], v[76:79], v[128:131], v[220:223]
    ds_read_b64 v[110:111], v28 offset:2440
    s_waitcnt lgkmcnt(11)
    v_mfma_f32_16x16x32_bf16 v[208:211], v[80:83], v[144:147], v[208:211]
    ds_read_b64 v[112:113], v28 offset:4032
    ds_read_b64 v[114:115], v28 offset:4040
    v_mfma_f32_16x16x32_bf16 v[212:215], v[80:83], v[148:151], v[212:215]
    ds_read_b128 v[176:179], v29 offset:2496
    v_mfma_f32_16x16x32_bf16 v[216:219], v[80:83], v[152:155], v[216:219]
    ds_read_b128 v[180:183], v29 offset:3008
    v_mfma_f32_16x16x32_bf16 v[220:223], v[80:83], v[156:159], v[220:223]
    ds_read_b128 v[184:187], v29 offset:3520
    v_mfma_f32_16x16x32_bf16 v[212:215], v[84:87], v[144:147], v[212:215]
    ds_read_b128 v[188:191], v29 offset:4032
    v_mfma_f32_16x16x32_bf16 v[216:219], v[84:87], v[148:151], v[216:219]
    ds_read_b64 v[116:117], v28 offset:3520
    ds_read_b64 v[118:119], v28 offset:3528
    v_mfma_f32_16x16x32_bf16 v[220:223], v[84:87], v[152:155], v[220:223]
    ds_read_b64 v[120:121], v28 offset:3008
    v_mfma_f32_16x16x32_bf16 v[216:219], v[88:91], v[144:147], v[216:219]
    ds_read_b64 v[122:123], v28 offset:3016
    v_mfma_f32_16x16x32_bf16 v[220:223], v[88:91], v[148:151], v[220:223]
    ds_read_b64 v[124:125], v28 offset:2496
    v_mfma_f32_16x16x32_bf16 v[220:223], v[92:95], v[144:147], v[220:223]
    ds_read_b64 v[126:127], v28 offset:2504
    s_waitcnt lgkmcnt(11)
    v_mfma_f32_16x16x32_bf16 v[208:211], v[96:99], v[160:163], v[208:211]
    v_mfma_f32_16x16x32_bf16 v[212:215], v[96:99], v[164:167], v[212:215]
    v_mfma_f32_16x16x32_bf16 v[216:219], v[96:99], v[168:171], v[216:219]
    v_mfma_f32_16x16x32_bf16 v[220:223], v[96:99], v[172:175], v[220:223]
    v_mfma_f32_16x16x32_bf16 v[212:215], v[100:103], v[160:163], v[212:215]
    v_mfma_f32_16x16x32_bf16 v[216:219], v[100:103], v[164:167], v[216:219]
    v_mfma_f32_16x16x32_bf16 v[220:223], v[100:103], v[168:171], v[220:223]
    v_mfma_f32_16x16x32_bf16 v[216:219], v[104:107], v[160:163], v[216:219]
    v_mfma_f32_16x16x32_bf16 v[220:223], v[104:107], v[164:167], v[220:223]
    v_mfma_f32_16x16x32_bf16 v[220:223], v[108:111], v[160:163], v[220:223]
    s_waitcnt lgkmcnt(8)
    v_mfma_f32_16x16x32_bf16 v[208:211], v[112:115], v[176:179], v[208:211]
    v_mfma_f32_16x16x32_bf16 v[212:215], v[112:115], v[180:183], v[212:215]
    s_waitcnt lgkmcnt(6)
    v_mfma_f32_16x16x32_bf16 v[216:219], v[112:115], v[184:187], v[216:219]
    v_mfma_f32_16x16x32_bf16 v[220:223], v[112:115], v[188:191], v[220:223]
    s_waitcnt lgkmcnt(4)
    v_mfma_f32_16x16x32_bf16 v[212:215], v[116:119], v[176:179], v[212:215]
    v_mfma_f32_16x16x32_bf16 v[216:219], v[116:119], v[180:183], v[216:219]
    v_mfma_f32_16x16x32_bf16 v[220:223], v[116:119], v[184:187], v[220:223]
    s_waitcnt lgkmcnt(2)
    v_mfma_f32_16x16x32_bf16 v[216:219], v[120:123], v[176:179], v[216:219]
    v_mfma_f32_16x16x32_bf16 v[220:223], v[120:123], v[180:183], v[220:223]
    s_waitcnt lgkmcnt(0)
    v_mfma_f32_16x16x32_bf16 v[220:223], v[124:127], v[176:179], v[220:223]
    v_cvt_pk_bf16_f32 v20, v208, v209
    v_cvt_pk_bf16_f32 v21, v210, v211
    ds_write_b32 v18, v20 offset:9120
    ds_write_b32 v18, v21 offset:9128
    v_cvt_pk_bf16_f32 v22, v212, v213
    v_cvt_pk_bf16_f32 v23, v214, v215
    ds_write_b32 v18, v22 offset:9760
    ds_write_b32 v18, v23 offset:9768
    v_cvt_pk_bf16_f32 v20, v216, v217
    v_cvt_pk_bf16_f32 v21, v218, v219
    ds_write_b32 v18, v20 offset:10400
    ds_write_b32 v18, v21 offset:10408
    v_cvt_pk_bf16_f32 v22, v220, v221
    v_cvt_pk_bf16_f32 v23, v222, v223
    ds_write_b32 v18, v22 offset:11040
    ds_write_b32 v18, v23 offset:11048
    s_cmp_lt_u32 s44, 4
    s_cbranch_scc0 L_B_nofillO
    ds_read_b128 v[224:227], v14 offset:0
    ds_read_b128 v[228:231], v14 offset:20464
    ds_read_b128 v[232:235], v14 offset:40928
    ds_read_b128 v[236:239], v14 offset:61392
    v_mov_b32 v16, s88
    v_mov_b32 v17, s90
    v_cndmask_b32 v16, v16, v17, s[78:79]
    v_lshlrev_b32 v24, 16, v16
    v_and_b32 v25, v7, v16
    v_mov_b32 v16, s89
    v_mov_b32 v17, s91
    v_cndmask_b32 v16, v16, v17, s[78:79]
    v_lshlrev_b32 v26, 16, v16
    v_and_b32 v27, v7, v16
    s_waitcnt lgkmcnt(0)
    v_lshlrev_b32 v32, 16, v224
    v_and_b32 v36, v7, v224
    v_mul_f32 v32, v24, v32
    v_mul_f32 v36, v24, v36
    v_cvt_pk_bf16_f32 v36, v32, v36
    v_lshlrev_b32 v32, 16, v36
    v_and_b32 v36, v7, v36
    v_lshlrev_b32 v40, 16, v225
    v_and_b32 v44, v7, v225
    v_mul_f32 v40, v24, v40
    v_mul_f32 v44, v24, v44
    v_cvt_pk_bf16_f32 v44, v40, v44
    v_lshlrev_b32 v40, 16, v44
    v_and_b32 v44, v7, v44
    v_lshlrev_b32 v48, 16, v226
    v_and_b32 v52, v7, v226
    v_mul_f32 v48, v24, v48
    v_mul_f32 v52, v24, v52
    v_cvt_pk_bf16_f32 v52, v48, v52
    v_lshlrev_b32 v48, 16, v52
    v_and_b32 v52, v7, v52
    v_lshlrev_b32 v56, 16, v227
    v_and_b32 v60, v7, v227
    v_mul_f32 v56, v24, v56
    v_mul_f32 v60, v24, v60
    v_cvt_pk_bf16_f32 v60, v56, v60
    v_lshlrev_b32 v56, 16, v60
    v_and_b32 v60, v7, v60
    v_lshlrev_b32 v33, 16, v228
    v_and_b32 v37, v7, v228
    v_mul_f32 v33, v25, v33
    v_mul_f32 v37, v25, v37
    v_cvt_pk_bf16_f32 v37, v33, v37
    v_lshlrev_b32 v33, 16, v37
    v_and_b32 v37, v7, v37
    v_lshlrev_b32 v41, 16, v229
    v_and_b32 v45, v7, v229
    v_mul_f32 v41, v25, v41
    v_mul_f32 v45, v25, v45
    v_cvt_pk_bf16_f32 v45, v41, v45
    v_lshlrev_b32 v41, 16, v45
    v_and_b32 v45, v7, v45
    v_lshlrev_b32 v49, 16, v230
    v_and_b32 v53, v7, v230
    v_mul_f32 v49, v25, v49
    v_mul_f32 v53, v25, v53
    v_cvt_pk_bf16_f32 v53, v49, v53
    v_lshlrev_b32 v49, 16, v53
    v_and_b32 v53, v7, v53
    v_lshlrev_b32 v57, 16, v231
    v_and_b32 v61, v7, v231
    v_mul_f32 v57, v25, v57
    v_mul_f32 v61, v25, v61
    v_cvt_pk_bf16_f32 v61, v57, v61
    v_lshlrev_b32 v57, 16, v61
    v_and_b32 v61, v7, v61
    v_lshlrev_b32 v34, 16, v232
    v_and_b32 v38, v7, v232
    v_mul_f32 v34, v26, v34
    v_mul_f32 v38, v26, v38
    v_cvt_pk_bf16_f32 v38, v34, v38
    v_lshlrev_b32 v34, 16, v38
    v_and_b32 v38, v7, v38
    v_lshlrev_b32 v42, 16, v233
    v_and_b32 v46, v7, v233
    v_mul_f32 v42, v26, v42
    v_mul_f32 v46, v26, v46
    v_cvt_pk_bf16_f32 v46, v42, v46
    v_lshlrev_b32 v42, 16, v46
    v_and_b32 v46, v7, v46
    v_lshlrev_b32 v50, 16, v234
    v_and_b32 v54, v7, v234
    v_mul_f32 v50, v26, v50
    v_mul_f32 v54, v26, v54
    v_cvt_pk_bf16_f32 v54, v50, v54
    v_lshlrev_b32 v50, 16, v54
    v_and_b32 v54, v7, v54
    v_lshlrev_b32 v58, 16, v235
    v_and_b32 v62, v7, v235
    v_mul_f32 v58, v26, v58
    v_mul_f32 v62, v26, v62
    v_cvt_pk_bf16_f32 v62, v58, v62
    v_lshlrev_b32 v58, 16, v62
    v_and_b32 v62, v7, v62
    v_lshlrev_b32 v35, 16, v236
    v_and_b32 v39, v7, v236
    v_mul_f32 v35, v27, v35
    v_mul_f32 v39, v27, v39
    v_cvt_pk_bf16_f32 v39, v35, v39
    v_lshlrev_b32 v35, 16, v39
    v_and_b32 v39, v7, v39
    v_lshlrev_b32 v43, 16, v237
    v_and_b32 v47, v7, v237
    v_mul_f32 v43, v27, v43
    v_mul_f32 v47, v27, v47
    v_cvt_pk_bf16_f32 v47, v43, v47
    v_lshlrev_b32 v43, 16, v47
    v_and_b32 v47, v7, v47
    v_lshlrev_b32 v51, 16, v238
    v_and_b32 v55, v7, v238
    v_mul_f32 v51, v27, v51
    v_mul_f32 v55, v27, v55
    v_cvt_pk_bf16_f32 v55, v51, v55
    v_lshlrev_b32 v51, 16, v55
    v_and_b32 v55, v7, v55
    v_lshlrev_b32 v59, 16, v239
    v_and_b32 v63, v7, v239
    v_mul_f32 v59, v27, v59
    v_mul_f32 v63, v27, v63
    v_cvt_pk_bf16_f32 v63, v59, v63
    v_lshlrev_b32 v59, 16, v63
    v_and_b32 v63, v7, v63
    v_lshrrev_b32 v10, 1, v0
    v_and_b32 v9, 127, v10
    v_lshrrev_b32 v8, 3, v9
    v_lshlrev_b32 v8, 5, v8
    v_lshl_add_u32 v8, v9, 4, v8
    v_and_b32 v9, 1, v0
    v_mul_u32_u24 v11, 81856, v9
    v_add_u32 v8, v8, v11
    s_cmp_lt_u32 s44, 4
    s_cselect_b32 s76, 8384, 0
    s_add_u32 s76, s76, 9120
    v_add_u32 v8, s76, v8
    v_mul_u32_u24 v11, 36864, v10
    v_lshl_add_u32 v11, v9, 4, v11
    s_lshl_b32 s76, s45, 5
    s_add_u32 s76, s76, 2304
    v_add_u32 v11, s76, v11
L_B_nofillO:
    s_waitcnt lgkmcnt(0)
    s_barrier
    ds_read_b128 v[64:67], v8 offset:0
    ds_read_b128 v[68:71], v8 offset:20464
    ds_read_b128 v[72:75], v8 offset:40928
    ds_read_b128 v[76:79], v8 offset:61392
    s_waitcnt lgkmcnt(0)
    v_lshlrev_b32 v16, 16, v64
    v_lshlrev_b32 v17, 16, v68
    v_lshlrev_b32 v18, 16, v72
    v_lshlrev_b32 v19, 16, v76
    v_add_f32 v32, v32, v16
    v_add_f32 v33, v33, v17
    v_add_f32 v34, v34, v18
    v_add_f32 v35, v35, v19
    v_cvt_pk_bf16_f32 v33, v32, v33
    v_cvt_pk_bf16_f32 v35, v34, v35
    v_lshlrev_b32 v32, 16, v33
    v_and_b32 v33, v7, v33
    v_lshlrev_b32 v34, 16, v35
    v_and_b32 v35, v7, v35
    s_mov_b32 s77, 0
    buffer_store_dwordx4 v[32:35], v11, s[72:75], s77 offen nt
    v_and_b32 v16, v7, v64
    v_and_b32 v17, v7, v68
    v_and_b32 v18, v7, v72
    v_and_b32 v19, v7, v76
    v_add_f32 v36, v36, v16
    v_add_f32 v37, v37, v17
    v_add_f32 v38, v38, v18
    v_add_f32 v39, v39, v19
    v_cvt_pk_bf16_f32 v37, v36, v37
    v_cvt_pk_bf16_f32 v39, v38, v39
    v_lshlrev_b32 v36, 16, v37
    v_and_b32 v37, v7, v37
    v_lshlrev_b32 v38, 16, v39
    v_and_b32 v39, v7, v39
    s_mov_b32 s77, 4608
    buffer_store_dwordx4 v[36:39], v11, s[72:75], s77 offen nt
    v_lshlrev_b32 v16, 16, v65
    v_lshlrev_b32 v17, 16, v69
    v_lshlrev_b32 v18, 16, v73
    v_lshlrev_b32 v19, 16, v77
    v_add_f32 v40, v40, v16
    v_add_f32 v41, v41, v17
    v_add_f32 v42, v42, v18
    v_add_f32 v43, v43, v19
    v_cvt_pk_bf16_f32 v41, v40, v41
    v_cvt_pk_bf16_f32 v43, v42, v43
    v_lshlrev_b32 v40, 16, v41
    v_and_b32 v41, v7, v41
    v_lshlrev_b32 v42, 16, v43
    v_and_b32 v43, v7, v43
    s_mov_b32 s77, 9216
    buffer_store_dwordx4 v[40:43], v11, s[72:75], s77 offen nt
    v_and_b32 v16, v7, v65
    v_and_b32 v17, v7, v69
    v_and_b32 v18, v7, v73
    v_and_b32 v19, v7, v77
    v_add_f32 v44, v44, v16
    v_add_f32 v45, v45, v17
    v_add_f32 v46, v46, v18
    v_add_f32 v47, v47, v19
    v_cvt_pk_bf16_f32 v45, v44, v45
    v_cvt_pk_bf16_f32 v47, v46, v47
    v_lshlrev_b32 v44, 16, v45
    v_and_b32 v45, v7, v45
    v_lshlrev_b32 v46, 16, v47
    v_and_b32 v47, v7, v47
    s_mov_b32 s77, 13824
    buffer_store_dwordx4 v[44:47], v11, s[72:75], s77 offen nt
    v_lshlrev_b32 v16, 16, v66
    v_lshlrev_b32 v17, 16, v70
    v_lshlrev_b32 v18, 16, v74
    v_lshlrev_b32 v19, 16, v78
    v_add_f32 v48, v48, v16
    v_add_f32 v49, v49, v17
    v_add_f32 v50, v50, v18
    v_add_f32 v51, v51, v19
    v_cvt_pk_bf16_f32 v49, v48, v49
    v_cvt_pk_bf16_f32 v51, v50, v51
    v_lshlrev_b32 v48, 16, v49
    v_and_b32 v49, v7, v49
    v_lshlrev_b32 v50, 16, v51
    v_and_b32 v51, v7, v51
    s_mov_b32 s77, 18432
    buffer_store_dwordx4 v[48:51], v11, s[72:75], s77 offen nt
    v_and_b32 v16, v7, v66
    v_and_b32 v17, v7, v70
    v_and_b32 v18, v7, v74
    v_and_b32 v19, v7, v78
    v_add_f32 v52, v52, v16
    v_add_f32 v53, v53, v17
    v_add_f32 v54, v54, v18
    v_add_f32 v55, v55, v19
    v_cvt_pk_bf16_f32 v53, v52, v53
    v_cvt_pk_bf16_f32 v55, v54, v55
    v_lshlrev_b32 v52, 16, v53
    v_and_b32 v53, v7, v53
    v_lshlrev_b32 v54, 16, v55
    v_and_b32 v55, v7, v55
    s_mov_b32 s77, 23040
    buffer_store_dwordx4 v[52:55], v11, s[72:75], s77 offen nt
    v_lshlrev_b32 v16, 16, v67
    v_lshlrev_b32 v17, 16, v71
    v_lshlrev_b32 v18, 16, v75
    v_lshlrev_b32 v19, 16, v79
    v_add_f32 v56, v56, v16
    v_add_f32 v57, v57, v17
    v_add_f32 v58, v58, v18
    v_add_f32 v59, v59, v19
    v_cvt_pk_bf16_f32 v57, v56, v57
    v_cvt_pk_bf16_f32 v59, v58, v59
    v_lshlrev_b32 v56, 16, v57
    v_and_b32 v57, v7, v57
    v_lshlrev_b32 v58, 16, v59
    v_and_b32 v59, v7, v59
    s_mov_b32 s77, 27648
    buffer_store_dwordx4 v[56:59], v11, s[72:75], s77 offen nt
    v_and_b32 v16, v7, v67
    v_and_b32 v17, v7, v71
    v_and_b32 v18, v7, v75
    v_and_b32 v19, v7, v79
    v_add_f32 v60, v60, v16
    v_add_f32 v61, v61, v17
    v_add_f32 v62, v62, v18
    v_add_f32 v63, v63, v19
    v_cvt_pk_bf16_f32 v61, v60, v61
    v_cvt_pk_bf16_f32 v63, v62, v63
    v_lshlrev_b32 v60, 16, v61
    v_and_b32 v61, v7, v61
    v_lshlrev_b32 v62, 16, v63
    v_and_b32 v63, v7, v63
    s_mov_b32 s77, 32256
    buffer_store_dwordx4 v[60:63], v11, s[72:75], s77 offen nt
    s_endpgm
L_end:
    s_endpgm
L_code_end:
.set CODE_BYTES, L_code_end - concat_heads__ssm_conv_s5__ssm_conv_s4d__prompt_kernel
.section .rodata,"a"
.p2align 6
.amdhsa_kernel concat_heads__ssm_conv_s5__ssm_conv_s4d__prompt_kernel
  .amdhsa_next_free_vgpr 256
  .amdhsa_next_free_sgpr 102
  .amdhsa_accum_offset 256
  .amdhsa_group_segment_fixed_size 0
  .amdhsa_kernarg_size 152
  .amdhsa_user_sgpr_count 2
  .amdhsa_user_sgpr_kernarg_segment_ptr 1
  .amdhsa_system_sgpr_workgroup_id_x 1
  .amdhsa_float_denorm_mode_32 3
.end_amdhsa_kernel
```
